```python
import torch

def _softmax(x, axis=-1):
    return torch.softmax(x, dim=axis)
def _gelu(x):
    return torch.nn.functional.gelu(x, approximate="tanh")
def _silu(x):
    return torch.nn.functional.silu(x)
def _sigmoid(x):
    return torch.sigmoid(x)
def _layernorm(x, axis=-1, eps=1e-5):
    m = x.mean(dim=axis, keepdim=True)
    v = x.var(dim=axis, keepdim=True, unbiased=False)
    return (x - m) / torch.sqrt(v + eps)
def _scatter_add(tgt, idx, src, axis=0):
    return tgt.clone().index_add_(axis, idx, src)
def _segment_sum(src, seg, n):
    out = torch.zeros((n,) + src.shape[1:], dtype=src.dtype)
    return out.index_add_(0, seg, src)
def _pad(x, pw):
    flat = tuple(v for pair in reversed(pw) for v in pair)
    return torch.nn.functional.pad(x, flat)

kernel_name = 'parallel_sum__spectral_gfnet__dense_activation_gelu__prompt'

def setup_inputs():

    _w = (lambda a: (lambda t: t.to(torch.bfloat16) if t.is_floating_point() else t)(torch.as_tensor(a)))
    def _A_setup():
        B, S, D = 1, 2048, 448
        Df = D // 2 + 1
        return {
            "x": _w((lambda *s: torch.randn(*s, dtype=torch.bfloat16) * 0.05)(B, S, D)),
            "w_r": _w((lambda *s: torch.randn(*s, dtype=torch.bfloat16) * 0.8)(S, Df) * 0.02),
            "w_i": _w((lambda *s: torch.randn(*s, dtype=torch.bfloat16) * 0.8)(S, Df) * 0.02),
        }
    _A_in = _A_setup()

    def _B_setup():
        B, S, D, F = 1, 2048, 448, 1792
        return {
            "x": _w((lambda *s: torch.randn(*s, dtype=torch.bfloat16) * 0.05)(B, S, D)),
            "w1": _w((lambda *s: torch.randn(*s, dtype=torch.bfloat16) * 0.4)(D, F) * (D ** -0.5)),
            "b1": _w((lambda *s: torch.randn(*s, dtype=torch.bfloat16) * 12.8)(F) * 0.01),
            "w2": _w((lambda *s: torch.randn(*s, dtype=torch.bfloat16) * 0.2)(F, D) * (F ** -0.5)),
            "b2": _w((lambda *s: torch.randn(*s, dtype=torch.bfloat16) * 1.6)(D) * 0.01),
        }
    _B_in = _B_setup()

    return {
        "A_x": _A_in["x"],
        "A_w_r": _A_in["w_r"],
        "A_w_i": _A_in["w_i"],
        "B_x": _B_in["x"],
        "B_w1": _B_in["w1"],
        "B_b1": _B_in["b1"],
        "B_w2": _B_in["w2"],
        "B_b2": _B_in["b2"],
    }

def reference(A_x, A_w_r, A_w_i, B_x, B_w1, B_b1, B_w2, B_b2):
    def _A_ref(x, w_r, w_i):
        B, S, D = x.shape
        X = (lambda x, axes=(-2,-1): torch.fft.rfft2(x.float(), dim=axes))(x, axes=(-2, -1))
        W = w_r + 1j * w_i
        X = X * W
        y = (lambda x, s, axes=(-2,-1): torch.fft.irfft2(x, s=s, dim=axes).to(torch.bfloat16))(X, (S, D), axes=(-2, -1))
        return y

    def _B_ref(x, w1, b1, w2, b2):
        h = torch.einsum("bsd,df->bsf", x, w1) + b1
        h = _gelu(h)
        return torch.einsum("bsf,fd->bsd", h, w2) + b2

    x = A_x
    xn = _layernorm(x, axis=-1)
    return x + _A_ref(xn, A_w_r, A_w_i) + _B_ref(xn, B_w1, B_b1, B_w2, B_b2)
```

```asm
; @launch grid=(256,1,1) block=(512,1,1) lds=160320
.amdgcn_target "amdgcn-amd-amdhsa--gfx950"
.text
.globl parallel_sum__spectral_gfnet__dense_activation_gelu__prompt_kernel
.p2align 8
.type parallel_sum__spectral_gfnet__dense_activation_gelu__prompt_kernel,@function
parallel_sum__spectral_gfnet__dense_activation_gelu__prompt_kernel:
s_cmp_ge_u32 s2, 256
s_cbranch_scc1 K1END_1
s_load_dwordx2 s[4:5], s[0:1], 0
s_load_dwordx4 s[8:11], s[0:1], 32
s_load_dwordx2 s[6:7], s[0:1], 48
s_load_dwordx4 s[28:31], s[0:1], 72
s_load_dwordx4 s[88:91], s[0:1], 8
v_lshrrev_b32 v1, 6, v0
v_and_b32 v0, 63, v0
s_and_b32 s42, s2, 7
s_lshr_b32 s43, s2, 3
v_readfirstlane_b32 s32, v1
s_mov_b32 s59, 200000
s_cmp_ge_u32 s43, 28
s_cbranch_scc1 K1SPARE_2
s_mul_i32 s33, s43, 37
s_lshr_b32 s33, s33, 8
s_mul_i32 s35, s33, 7
s_sub_u32 s35, s43, s35
s_lshl_b32 s50, s33, 1
s_add_u32 s50, s50, s35
s_sub_u32 s38, s50, 7
s_cselect_b32 s50, s50, s38
s_lshr_b32 s34, s42, 1
s_lshl_b32 s34, s34, 2
s_add_u32 s34, s34, s33
s_and_b32 s38, s42, 1
s_mul_i32 s38, s38, 7
s_add_u32 s35, s35, s38
s_and_b32 s36, s32, 3
s_lshr_b32 s37, s32, 2
s_mov_b32 s51, s50
s_lshl_b32 s52, s51, 7
s_mul_i32 s60, s51, 229376
s_add_u32 s51, s51, 1
s_cmp_eq_u32 s51, 7
s_cselect_b32 s51, 0, s51
s_lshl_b32 s53, s51, 7
s_mul_i32 s61, s51, 229376
s_add_u32 s51, s51, 1
s_cmp_eq_u32 s51, 7
s_cselect_b32 s51, 0, s51
s_lshl_b32 s54, s51, 7
s_mul_i32 s62, s51, 229376
s_add_u32 s51, s51, 1
s_cmp_eq_u32 s51, 7
s_cselect_b32 s51, 0, s51
s_lshl_b32 s55, s51, 7
s_mul_i32 s63, s51, 229376
s_add_u32 s51, s51, 1
s_cmp_eq_u32 s51, 7
s_cselect_b32 s51, 0, s51
s_lshl_b32 s56, s51, 7
s_mul_i32 s64, s51, 229376
s_add_u32 s51, s51, 1
s_cmp_eq_u32 s51, 7
s_cselect_b32 s51, 0, s51
s_lshl_b32 s57, s51, 7
s_mul_i32 s65, s51, 229376
s_add_u32 s51, s51, 1
s_cmp_eq_u32 s51, 7
s_cselect_b32 s51, 0, s51
s_lshl_b32 s58, s51, 7
s_mul_i32 s66, s51, 229376
v_lshrrev_b32 v4, 3, v0
s_and_b32 s38, s32, 1
s_lshl_b32 s38, s38, 4
v_add_u32 v4, s38, v4
v_lshrrev_b32 v5, 1, v4
v_and_b32 v5, 7, v5
v_and_b32 v6, 7, v0
v_xor_b32 v5, v5, v6
v_lshlrev_b32 v5, 4, v5
v_mul_u32_u24 v4, 57344, v4
s_lshr_b32 s38, s32, 1
s_lshl_b32 s39, s34, 2
s_add_u32 s38, s38, s39
s_mul_i32 s38, s38, 896
v_add_u32 v4, s38, v4
v_add_u32 v2, v4, v5
v_xor_b32 v5, 64, v5
v_add_u32 v3, v4, v5
v_add_u32 v3, 458752, v3
v_lshrrev_b32 v4, 3, v0
v_and_b32 v5, 2, v4
v_lshlrev_b32 v5, 1, v5
v_xor_b32 v5, v5, v6
v_lshlrev_b32 v5, 4, v5
s_lshl_b32 s38, s32, 3
v_add_u32 v4, s38, v4
v_mul_u32_u24 v4, 3584, v4
s_lshl_b32 s38, s35, 8
v_add3_u32 v4, v4, v5, s38
s_lshl_b32 s40, s32, 11
s_lshl_b32 s41, s32, 10
v_and_b32 v5, 31, v0
s_lshl_b32 s38, s35, 7
s_lshl_b32 s39, s37, 5
s_add_u32 s38, s38, s39
v_add_lshl_u32 v7, v5, s38, 1
v_lshrrev_b32 v6, 5, v0
v_and_b32 v10, 15, v0
s_lshl_b32 s38, s35, 4
v_add_u32 v10, s38, v10
v_bfe_u32 v11, v0, 4, 1
v_cvt_f32_u32 v12, v11
v_mul_f32 v12, 0.25, v12
v_add_u32 v13, s38, v5
v_cmp_eq_u32 vcc, 16, v13
s_cmp_eq_u32 s35, 0
s_cselect_b64 vcc, vcc, 0
v_mov_b32 v14, 224
v_cndmask_b32 v10, v10, v14, vcc
v_cndmask_b32 v12, v12, 0, vcc
v_cvt_f32_u32 v10, v10
v_mul_f32 v10, 0x3b124925, v10
v_lshlrev_b32 v13, 3, v6
s_lshl_b32 s38, s36, 4
v_add_u32 v13, s38, v13
v_cvt_f32_u32 v13, v13
v_fma_f32 v13, v13, v10, v12
v_lshlrev_b32 v29, 4, v0
v_add_u32 v35, 122880, v29
v_add_u32 v14, s41, v35
s_waitcnt lgkmcnt(0)
s_mov_b32 s12, s4
s_mov_b32 s13, s5
s_mov_b32 s14, 0x1c0000
s_mov_b32 s15, 0x20000
s_mov_b32 s16, s8
s_mov_b32 s17, s9
s_mov_b32 s18, 0x188000
s_mov_b32 s19, 0x20000
s_add_u32 m0, s40, 0
s_nop 0
buffer_load_dwordx4 v2, s[12:15], s52 offen lds
s_add_u32 m0, s40, 1024
s_nop 0
buffer_load_dwordx4 v3, s[12:15], s52 offen lds
s_add_u32 m0, s41, 16384
s_nop 0
buffer_load_dwordx4 v4, s[16:19], s60 offen lds
s_add_u32 m0, s40, 24576
s_nop 0
buffer_load_dwordx4 v2, s[12:15], s53 offen lds
s_add_u32 m0, s40, 25600
s_nop 0
buffer_load_dwordx4 v3, s[12:15], s53 offen lds
s_add_u32 m0, s41, 40960
s_nop 0
buffer_load_dwordx4 v4, s[16:19], s61 offen lds
s_mov_b32 s24, s10
s_mov_b32 s25, s11
s_mov_b32 s26, 0xe00
s_mov_b32 s27, 0x20000
s_add_u32 s38, s50, s37
s_add_u32 s38, s38, 0
s_sub_u32 s39, s38, 7
s_cselect_b32 s38, s38, s39
s_lshl_b32 s38, s38, 6
v_cvt_f32_u32 v27, s38
v_fma_f32 v27, v27, v10, v13
v_fmamk_f32 v16, v10, 0x00000000, v27
v_fmamk_f32 v17, v10, 0x3f800000, v27
v_fmamk_f32 v18, v10, 0x40000000, v27
v_fmamk_f32 v19, v10, 0x40400000, v27
v_fmamk_f32 v20, v10, 0x40800000, v27
v_fmamk_f32 v21, v10, 0x40a00000, v27
v_fmamk_f32 v22, v10, 0x40c00000, v27
v_fmamk_f32 v23, v10, 0x40e00000, v27
v_cos_f32 v16, v16
v_cos_f32 v17, v17
v_cos_f32 v18, v18
v_cos_f32 v19, v19
v_cos_f32 v20, v20
v_cos_f32 v21, v21
v_cos_f32 v22, v22
v_cos_f32 v23, v23
s_nop 0
v_cvt_pk_bf16_f32 v24, v16, v17
v_cvt_pk_bf16_f32 v25, v18, v19
v_cvt_pk_bf16_f32 v26, v20, v21
v_cvt_pk_bf16_f32 v27, v22, v23
ds_write_b128 v14, v[24:27] offset:0
s_add_u32 m0, s40, 49152
s_nop 0
buffer_load_dwordx4 v2, s[12:15], s54 offen lds
s_add_u32 m0, s40, 50176
s_nop 0
buffer_load_dwordx4 v3, s[12:15], s54 offen lds
s_add_u32 m0, s41, 65536
s_nop 0
buffer_load_dwordx4 v4, s[16:19], s62 offen lds
buffer_load_ushort v8, v7, s[24:27], 0 offen
buffer_load_ushort v9, v7, s[24:27], 0 offen offset:128
s_add_u32 s38, s50, s37
s_add_u32 s38, s38, 2
s_sub_u32 s39, s38, 7
s_cselect_b32 s38, s38, s39
s_lshl_b32 s38, s38, 6
v_cvt_f32_u32 v27, s38
v_fma_f32 v27, v27, v10, v13
v_fmamk_f32 v16, v10, 0x00000000, v27
v_fmamk_f32 v17, v10, 0x3f800000, v27
v_fmamk_f32 v18, v10, 0x40000000, v27
v_fmamk_f32 v19, v10, 0x40400000, v27
v_fmamk_f32 v20, v10, 0x40800000, v27
v_fmamk_f32 v21, v10, 0x40a00000, v27
v_fmamk_f32 v22, v10, 0x40c00000, v27
v_fmamk_f32 v23, v10, 0x40e00000, v27
v_cos_f32 v16, v16
v_cos_f32 v17, v17
v_cos_f32 v18, v18
v_cos_f32 v19, v19
v_cos_f32 v20, v20
v_cos_f32 v21, v21
v_cos_f32 v22, v22
v_cos_f32 v23, v23
s_nop 0
v_cvt_pk_bf16_f32 v24, v16, v17
v_cvt_pk_bf16_f32 v25, v18, v19
v_cvt_pk_bf16_f32 v26, v20, v21
v_cvt_pk_bf16_f32 v27, v22, v23
ds_write_b128 v14, v[24:27] offset:8192
s_add_u32 m0, s40, 73728
s_nop 0
buffer_load_dwordx4 v2, s[12:15], s55 offen lds
s_add_u32 m0, s40, 74752
s_nop 0
buffer_load_dwordx4 v3, s[12:15], s55 offen lds
s_add_u32 m0, s41, 90112
s_nop 0
buffer_load_dwordx4 v4, s[16:19], s63 offen lds
s_mov_b32 s20, s30
s_mov_b32 s21, s31
s_mov_b32 s22, 0xd40000
s_mov_b32 s23, 0x20000
s_lshl_b32 s38, s34, 2
s_add_u32 s44, s38, s36
s_mul_i32 s38, s44, 112
s_lshl_b32 s39, s35, 3
s_add_u32 s38, s38, s39
s_lshl_b32 s39, s37, 1
s_add_u32 s38, s38, s39
s_lshl_b32 s45, s38, 10
s_add_u32 s46, s45, 4096
s_mul_i32 s38, s34, 14
s_add_u32 s38, s38, s35
s_cmp_lt_u32 s32, 4
s_cbranch_scc1 PFD
s_cmp_eq_u32 s32, 7
s_cbranch_scc1 PFD
s_cmp_eq_u32 s32, 6
s_cbranch_scc1 PF6
s_mul_i32 s38, s38, 4224
v_min_u32 v15, 32, v0
s_cmp_eq_u32 s32, 5
s_cbranch_scc1 PF5
s_mov_b32 s20, s88
s_mov_b32 s21, s89
s_mov_b32 s22, 0xe1000
s_mov_b32 s23, 0x20000
s_branch PFG
PF5:
s_mov_b32 s20, s90
s_mov_b32 s21, s91
s_mov_b32 s22, 0xe1000
s_mov_b32 s23, 0x20000
s_branch PFG
PF6:
s_mul_i32 s38, s38, 7168
v_min_u32 v15, 55, v0
s_mov_b32 s20, s6
s_mov_b32 s21, s7
s_mov_b32 s22, 0x188000
s_mov_b32 s23, 0x20000
PFG:
v_lshlrev_b32 v15, 7, v15
buffer_load_dword v47, v15, s[20:23], s38 offen
s_branch PFE
PFD:
buffer_load_ushort v47, v7, s[24:27], 0 offen
PFE:
s_add_u32 s38, s50, s37
s_add_u32 s38, s38, 4
s_sub_u32 s39, s38, 7
s_cselect_b32 s38, s38, s39
s_lshl_b32 s38, s38, 6
v_cvt_f32_u32 v27, s38
v_fma_f32 v27, v27, v10, v13
v_fmamk_f32 v16, v10, 0x00000000, v27
v_fmamk_f32 v17, v10, 0x3f800000, v27
v_fmamk_f32 v18, v10, 0x40000000, v27
v_fmamk_f32 v19, v10, 0x40400000, v27
v_fmamk_f32 v20, v10, 0x40800000, v27
v_fmamk_f32 v21, v10, 0x40a00000, v27
v_fmamk_f32 v22, v10, 0x40c00000, v27
v_fmamk_f32 v23, v10, 0x40e00000, v27
v_cos_f32 v16, v16
v_cos_f32 v17, v17
v_cos_f32 v18, v18
v_cos_f32 v19, v19
v_cos_f32 v20, v20
v_cos_f32 v21, v21
v_cos_f32 v22, v22
v_cos_f32 v23, v23
s_nop 0
v_cvt_pk_bf16_f32 v24, v16, v17
v_cvt_pk_bf16_f32 v25, v18, v19
v_cvt_pk_bf16_f32 v26, v20, v21
v_cvt_pk_bf16_f32 v27, v22, v23
ds_write_b128 v14, v[24:27] offset:16384
s_mov_b32 s20, s30
s_mov_b32 s21, s31
s_mov_b32 s22, 0xd40000
s_mov_b32 s23, 0x20000
s_mov_b32 s24, s28
s_mov_b32 s25, s29
s_mov_b32 s26, 0x100
s_mov_b32 s27, 0x20000
v_mov_b32 v11, 160256
v_mov_b32 v12, 0
v_mov_b32 v15, 0
ds_write2_b32 v11, v12, v15 offset0:0 offset1:1
ds_write2_b32 v11, v12, v15 offset0:2 offset1:3
s_lshl_b32 s47, s34, 4
s_add_u32 s47, s47, s35
s_lshl_b32 s47, s47, 8
s_add_u32 s47, s47, 13631488
v_lshlrev_b32 v28, 2, v0
v_lshrrev_b32 v11, 1, v5
v_and_b32 v11, 7, v11
v_xor_b32 v11, v11, v6
v_lshlrev_b32 v15, 4, v11
s_lshl_b32 s38, s36, 12
v_lshl_add_u32 v11, v5, 7, s38
v_xor_b32 v12, 0, v15
v_add_u32 v30, v11, v12
v_xor_b32 v12, 32, v15
v_add_u32 v31, v11, v12
v_xor_b32 v12, 64, v15
v_add_u32 v32, v11, v12
v_xor_b32 v12, 96, v15
v_add_u32 v33, v11, v12
v_bfe_u32 v15, v0, 2, 2
v_lshl_add_u32 v11, v6, 3, v15
v_lshlrev_b32 v11, 7, v11
v_and_b32 v12, 3, v0
v_lshlrev_b32 v12, 3, v12
v_bfe_u32 v7, v0, 4, 1
v_lshl_add_u32 v12, v7, 5, v12
s_lshl_b32 s38, s37, 6
v_add_u32 v12, s38, v12
v_and_b32 v7, 2, v15
v_lshlrev_b32 v7, 5, v7
v_xor_b32 v12, v12, v7
v_add_u32 v34, v11, v12
v_mov_b32 v38, 0x3f803f80
v_mov_b32 v39, 0x3f803f80
v_add_u32 v40, 65536, v30
v_add_u32 v41, 65536, v31
v_add_u32 v42, 65536, v32
v_add_u32 v43, 65536, v33
v_add_u32 v44, 65536, v34
s_cmp_eq_u32 s37, 1
s_cbranch_scc1 CG1_3
s_add_u32 s38, s50, s37
s_add_u32 s38, s38, 6
s_sub_u32 s39, s38, 7
s_cselect_b32 s38, s38, s39
s_lshl_b32 s38, s38, 6
v_cvt_f32_u32 v27, s38
v_fma_f32 v27, v27, v10, v13
v_fmamk_f32 v16, v10, 0x00000000, v27
v_fmamk_f32 v17, v10, 0x3f800000, v27
v_fmamk_f32 v18, v10, 0x40000000, v27
v_fmamk_f32 v19, v10, 0x40400000, v27
v_fmamk_f32 v20, v10, 0x40800000, v27
v_fmamk_f32 v21, v10, 0x40a00000, v27
v_fmamk_f32 v22, v10, 0x40c00000, v27
v_fmamk_f32 v23, v10, 0x40e00000, v27
v_cos_f32 v16, v16
v_cos_f32 v17, v17
v_cos_f32 v18, v18
v_cos_f32 v19, v19
v_cos_f32 v20, v20
v_cos_f32 v21, v21
v_cos_f32 v22, v22
v_cos_f32 v23, v23
s_nop 0
v_cvt_pk_bf16_f32 v24, v16, v17
v_cvt_pk_bf16_f32 v25, v18, v19
v_cvt_pk_bf16_f32 v26, v20, v21
v_cvt_pk_bf16_f32 v27, v22, v23
ds_write_b128 v14, v[24:27] offset:24576
v_cvt_f32_u32 v10, v5
v_mul_f32 v10, 0x3a000000, v10
v_lshlrev_b32 v11, 8, v6
v_add_u32 v11, s44, v11
v_cvt_f32_u32 v11, v11
v_mul_f32 v11, v11, v10
v_fmamk_f32 v240, v10, 0x00000000, v11
v_fmamk_f32 v241, v10, 0x42800000, v11
v_fmamk_f32 v242, v10, 0x43000000, v11
v_fmamk_f32 v243, v10, 0x43400000, v11
v_fmamk_f32 v244, v10, 0x44000000, v11
v_fmamk_f32 v245, v10, 0x44100000, v11
v_fmamk_f32 v246, v10, 0x44200000, v11
v_fmamk_f32 v247, v10, 0x44300000, v11
v_sin_f32 v248, v240
v_sin_f32 v249, v241
v_sin_f32 v250, v242
v_sin_f32 v251, v243
v_sin_f32 v252, v244
v_sin_f32 v253, v245
v_sin_f32 v254, v246
v_sin_f32 v255, v247
v_cos_f32 v240, v240
v_cos_f32 v241, v241
v_cos_f32 v242, v242
v_cos_f32 v243, v243
v_cos_f32 v244, v244
v_cos_f32 v245, v245
v_cos_f32 v246, v246
v_cos_f32 v247, v247
s_nop 0
v_cvt_pk_bf16_f32 v80, v240, v241
v_cvt_pk_bf16_f32 v81, v242, v243
v_cvt_pk_bf16_f32 v82, v244, v245
v_cvt_pk_bf16_f32 v83, v246, v247
v_cvt_pk_bf16_f32 v88, v248, v249
v_cvt_pk_bf16_f32 v89, v250, v251
v_cvt_pk_bf16_f32 v90, v252, v253
v_cvt_pk_bf16_f32 v91, v254, v255
v_fmamk_f32 v240, v10, 0x44800000, v11
v_fmamk_f32 v241, v10, 0x44880000, v11
v_fmamk_f32 v242, v10, 0x44900000, v11
v_fmamk_f32 v243, v10, 0x44980000, v11
v_fmamk_f32 v244, v10, 0x44c00000, v11
v_fmamk_f32 v245, v10, 0x44c80000, v11
v_fmamk_f32 v246, v10, 0x44d00000, v11
v_fmamk_f32 v247, v10, 0x44d80000, v11
v_sin_f32 v248, v240
v_sin_f32 v249, v241
v_sin_f32 v250, v242
v_sin_f32 v251, v243
v_sin_f32 v252, v244
v_sin_f32 v253, v245
v_sin_f32 v254, v246
v_sin_f32 v255, v247
v_cos_f32 v240, v240
v_cos_f32 v241, v241
v_cos_f32 v242, v242
v_cos_f32 v243, v243
v_cos_f32 v244, v244
v_cos_f32 v245, v245
v_cos_f32 v246, v246
v_cos_f32 v247, v247
s_nop 0
v_cvt_pk_bf16_f32 v84, v240, v241
v_cvt_pk_bf16_f32 v85, v242, v243
v_cvt_pk_bf16_f32 v86, v244, v245
v_cvt_pk_bf16_f32 v87, v246, v247
v_cvt_pk_bf16_f32 v92, v248, v249
v_cvt_pk_bf16_f32 v93, v250, v251
v_cvt_pk_bf16_f32 v94, v252, v253
v_cvt_pk_bf16_f32 v95, v254, v255
v_mov_b32 v16, -1
v_mov_b32 v17, -1
v_mov_b32 v18, -1
v_mov_b32 v19, -1
s_waitcnt vmcnt(12) lgkmcnt(0)
s_barrier
ds_read_b128 v[128:131], v30 offset:0
ds_read_b64_tr_b16 v[64:65], v34 offset:16384
ds_read_b64_tr_b16 v[66:67], v34 offset:16896
ds_read_b128 v[48:51], v35 offset:0
ds_read_b128 v[132:135], v31 offset:0
ds_read_b64_tr_b16 v[68:69], v34 offset:18432
ds_read_b64_tr_b16 v[70:71], v34 offset:18944
ds_read_b128 v[52:55], v35 offset:1024
ds_read_b128 v[136:139], v32 offset:0
ds_read_b64_tr_b16 v[72:73], v34 offset:20480
ds_read_b64_tr_b16 v[74:75], v34 offset:20992
ds_read_b128 v[56:59], v35 offset:2048
ds_read_b128 v[140:143], v33 offset:0
ds_read_b64_tr_b16 v[76:77], v34 offset:22528
ds_read_b64_tr_b16 v[78:79], v34 offset:23040
ds_read_b128 v[60:63], v35 offset:3072
s_waitcnt lgkmcnt(12)
v_mfma_f32_32x32x16_bf16 v[96:111], v[64:67], v[128:131], 0
v_mfma_f32_32x32x16_bf16 v[112:127], v[128:131], v[48:51], 0
s_cmp_lg_u32 s36, 0
s_cbranch_scc1 L_4
v_mfma_f32_4x4x4_16b_bf16 v[240:243], v[38:39], v[64:65], 0
v_mfma_f32_4x4x4_16b_bf16 v[244:247], v[38:39], v[66:67], 0
L_4:
s_add_u32 m0, s40, 98304
s_nop 0
buffer_load_dwordx4 v2, s[12:15], s56 offen lds
s_add_u32 m0, s40, 99328
s_nop 0
buffer_load_dwordx4 v3, s[12:15], s56 offen lds
s_waitcnt lgkmcnt(8)
v_mfma_f32_32x32x16_bf16 v[96:111], v[68:71], v[132:135], v[96:111]
v_mfma_f32_32x32x16_bf16 v[112:127], v[132:135], v[52:55], v[112:127]
s_cmp_lg_u32 s36, 1
s_cbranch_scc1 L_5
v_mfma_f32_4x4x4_16b_bf16 v[240:243], v[38:39], v[68:69], 0
v_mfma_f32_4x4x4_16b_bf16 v[244:247], v[38:39], v[70:71], 0
L_5:
s_add_u32 m0, s41, 114688
s_nop 0
buffer_load_dwordx4 v4, s[16:19], s64 offen lds
s_waitcnt vmcnt(12) lgkmcnt(0)
s_barrier
ds_read_b128 v[144:147], v30 offset:24576
ds_read_b64_tr_b16 v[64:65], v34 offset:40960
ds_read_b64_tr_b16 v[66:67], v34 offset:41472
ds_read_b128 v[48:51], v35 offset:4096
ds_read_b128 v[148:151], v31 offset:24576
ds_read_b64_tr_b16 v[68:69], v34 offset:43008
ds_read_b64_tr_b16 v[70:71], v34 offset:43520
ds_read_b128 v[52:55], v35 offset:5120
s_waitcnt lgkmcnt(15)
v_mfma_f32_32x32x16_bf16 v[96:111], v[72:75], v[136:139], v[96:111]
v_mfma_f32_32x32x16_bf16 v[112:127], v[136:139], v[56:59], v[112:127]
s_cmp_lg_u32 s36, 2
s_cbranch_scc1 L_6
v_mfma_f32_4x4x4_16b_bf16 v[240:243], v[38:39], v[72:73], 0
v_mfma_f32_4x4x4_16b_bf16 v[244:247], v[38:39], v[74:75], 0
L_6:
s_add_u32 m0, s40, 0
s_nop 0
buffer_load_dwordx4 v2, s[12:15], s57 offen lds
s_add_u32 m0, s40, 1024
s_nop 0
buffer_load_dwordx4 v3, s[12:15], s57 offen lds
s_waitcnt lgkmcnt(15)
v_mfma_f32_32x32x16_bf16 v[96:111], v[76:79], v[140:143], v[96:111]
v_mfma_f32_32x32x16_bf16 v[112:127], v[140:143], v[60:63], v[112:127]
s_cmp_lg_u32 s36, 3
s_cbranch_scc1 L_7
v_mfma_f32_4x4x4_16b_bf16 v[240:243], v[38:39], v[76:77], 0
v_mfma_f32_4x4x4_16b_bf16 v[244:247], v[38:39], v[78:79], 0
L_7:
s_lshl_b32 s38, s35, 3
s_add_u32 s38, s38, s32
s_mul_i32 s39, s38, 147
s_lshr_b32 s39, s39, 12
s_lshl_b32 s39, s39, 2
s_add_u32 s38, s38, s39
s_lshl_b32 s39, s34, 7
s_add_u32 s38, s38, s39
s_lshl_b32 s38, s38, 10
s_add_u32 s38, s38, 11534336
buffer_store_dwordx4 v[16:19], v29, s[20:23], s38 offen sc1
s_or_b32 s38, s35, s36
s_cmp_lg_u32 s38, 0
s_cbranch_scc1 NOV
v_lshrrev_b32 v12, 3, v5
v_and_b32 v15, 7, v5
v_lshlrev_b32 v12, 15, v12
v_lshl_add_u32 v12, v15, 9, v12
s_lshl_b32 s38, s34, 17
s_add_u32 s38, s38, 11563008
buffer_store_dwordx4 v[16:19], v12, s[20:23], s38 offen sc1
NOV:
s_add_u32 m0, s41, 16384
s_nop 0
buffer_load_dwordx4 v4, s[16:19], s65 offen lds
ds_read_b128 v[152:155], v32 offset:24576
ds_read_b64_tr_b16 v[72:73], v34 offset:45056
ds_read_b64_tr_b16 v[74:75], v34 offset:45568
ds_read_b128 v[56:59], v35 offset:6144
ds_read_b128 v[156:159], v33 offset:24576
ds_read_b64_tr_b16 v[76:77], v34 offset:47104
ds_read_b64_tr_b16 v[78:79], v34 offset:47616
ds_read_b128 v[60:63], v35 offset:7168
s_waitcnt lgkmcnt(12)
v_mfma_f32_32x32x16_bf16 v[96:111], v[64:67], v[144:147], v[96:111]
v_mfma_f32_32x32x16_bf16 v[112:127], v[144:147], v[48:51], v[112:127]
s_cmp_lg_u32 s36, 0
s_cbranch_scc1 L_8
v_mfma_f32_4x4x4_16b_bf16 v[240:243], v[38:39], v[64:65], v[240:243]
v_mfma_f32_4x4x4_16b_bf16 v[244:247], v[38:39], v[66:67], v[244:247]
L_8:
s_waitcnt lgkmcnt(8)
v_mfma_f32_32x32x16_bf16 v[96:111], v[68:71], v[148:151], v[96:111]
v_mfma_f32_32x32x16_bf16 v[112:127], v[148:151], v[52:55], v[112:127]
s_cmp_lg_u32 s36, 1
s_cbranch_scc1 L_9
v_mfma_f32_4x4x4_16b_bf16 v[240:243], v[38:39], v[68:69], v[240:243]
v_mfma_f32_4x4x4_16b_bf16 v[244:247], v[38:39], v[70:71], v[244:247]
L_9:
s_waitcnt vmcnt(13) lgkmcnt(0)
s_barrier
ds_read_b128 v[160:163], v30 offset:49152
ds_read_b64_tr_b16 v[64:65], v44 offset:0
ds_read_b64_tr_b16 v[66:67], v44 offset:512
ds_read_b128 v[48:51], v35 offset:8192
ds_read_b128 v[164:167], v31 offset:49152
ds_read_b64_tr_b16 v[68:69], v44 offset:2048
ds_read_b64_tr_b16 v[70:71], v44 offset:2560
ds_read_b128 v[52:55], v35 offset:9216
s_waitcnt lgkmcnt(15)
v_mfma_f32_32x32x16_bf16 v[96:111], v[72:75], v[152:155], v[96:111]
v_mfma_f32_32x32x16_bf16 v[112:127], v[152:155], v[56:59], v[112:127]
s_cmp_lg_u32 s36, 2
s_cbranch_scc1 L_10
v_mfma_f32_4x4x4_16b_bf16 v[240:243], v[38:39], v[72:73], v[240:243]
v_mfma_f32_4x4x4_16b_bf16 v[244:247], v[38:39], v[74:75], v[244:247]
L_10:
s_add_u32 m0, s40, 24576
s_nop 0
buffer_load_dwordx4 v2, s[12:15], s58 offen lds
s_add_u32 m0, s40, 25600
s_nop 0
buffer_load_dwordx4 v3, s[12:15], s58 offen lds
s_waitcnt lgkmcnt(15)
v_mfma_f32_32x32x16_bf16 v[96:111], v[76:79], v[156:159], v[96:111]
v_mfma_f32_32x32x16_bf16 v[112:127], v[156:159], v[60:63], v[112:127]
s_cmp_lg_u32 s36, 3
s_cbranch_scc1 L_11
v_mfma_f32_4x4x4_16b_bf16 v[240:243], v[38:39], v[76:77], v[240:243]
v_mfma_f32_4x4x4_16b_bf16 v[244:247], v[38:39], v[78:79], v[244:247]
L_11:
s_add_u32 m0, s41, 40960
s_nop 0
buffer_load_dwordx4 v4, s[16:19], s66 offen lds
ds_read_b128 v[168:171], v32 offset:49152
ds_read_b64_tr_b16 v[72:73], v44 offset:4096
ds_read_b64_tr_b16 v[74:75], v44 offset:4608
ds_read_b128 v[56:59], v35 offset:10240
ds_read_b128 v[172:175], v33 offset:49152
ds_read_b64_tr_b16 v[76:77], v44 offset:6144
ds_read_b64_tr_b16 v[78:79], v44 offset:6656
ds_read_b128 v[60:63], v35 offset:11264
s_waitcnt lgkmcnt(12)
v_mfma_f32_32x32x16_bf16 v[96:111], v[64:67], v[160:163], v[96:111]
v_mfma_f32_32x32x16_bf16 v[112:127], v[160:163], v[48:51], v[112:127]
s_cmp_lg_u32 s36, 0
s_cbranch_scc1 L_12
v_mfma_f32_4x4x4_16b_bf16 v[240:243], v[38:39], v[64:65], v[240:243]
v_mfma_f32_4x4x4_16b_bf16 v[244:247], v[38:39], v[66:67], v[244:247]
L_12:
s_waitcnt lgkmcnt(8)
v_mfma_f32_32x32x16_bf16 v[96:111], v[68:71], v[164:167], v[96:111]
v_mfma_f32_32x32x16_bf16 v[112:127], v[164:167], v[52:55], v[112:127]
s_cmp_lg_u32 s36, 1
s_cbranch_scc1 L_13
v_mfma_f32_4x4x4_16b_bf16 v[240:243], v[38:39], v[68:69], v[240:243]
v_mfma_f32_4x4x4_16b_bf16 v[244:247], v[38:39], v[70:71], v[244:247]
L_13:
s_waitcnt vmcnt(11) lgkmcnt(0)
s_barrier
ds_read_b128 v[176:179], v40 offset:8192
ds_read_b64_tr_b16 v[64:65], v44 offset:24576
ds_read_b64_tr_b16 v[66:67], v44 offset:25088
ds_read_b128 v[48:51], v35 offset:12288
ds_read_b128 v[180:183], v41 offset:8192
ds_read_b64_tr_b16 v[68:69], v44 offset:26624
ds_read_b64_tr_b16 v[70:71], v44 offset:27136
ds_read_b128 v[52:55], v35 offset:13312
s_waitcnt lgkmcnt(15)
v_mfma_f32_32x32x16_bf16 v[96:111], v[72:75], v[168:171], v[96:111]
v_mfma_f32_32x32x16_bf16 v[112:127], v[168:171], v[56:59], v[112:127]
s_cmp_lg_u32 s36, 2
s_cbranch_scc1 L_14
v_mfma_f32_4x4x4_16b_bf16 v[240:243], v[38:39], v[72:73], v[240:243]
v_mfma_f32_4x4x4_16b_bf16 v[244:247], v[38:39], v[74:75], v[244:247]
L_14:
s_add_u32 m0, s41, 49024
s_nop 0
buffer_load_dwordx4 v4, s[16:19], s60 offen offset:128 lds
s_add_u32 m0, s41, 57216
s_nop 0
buffer_load_dwordx4 v4, s[16:19], s61 offen offset:128 lds
s_waitcnt lgkmcnt(15)
v_mfma_f32_32x32x16_bf16 v[96:111], v[76:79], v[172:175], v[96:111]
v_mfma_f32_32x32x16_bf16 v[112:127], v[172:175], v[60:63], v[112:127]
s_cmp_lg_u32 s36, 3
s_cbranch_scc1 L_15
v_mfma_f32_4x4x4_16b_bf16 v[240:243], v[38:39], v[76:77], v[240:243]
v_mfma_f32_4x4x4_16b_bf16 v[244:247], v[38:39], v[78:79], v[244:247]
L_15:
s_add_u32 m0, s41, 65408
s_nop 0
buffer_load_dwordx4 v4, s[16:19], s62 offen offset:128 lds
ds_read_b128 v[184:187], v42 offset:8192
ds_read_b64_tr_b16 v[72:73], v44 offset:28672
ds_read_b64_tr_b16 v[74:75], v44 offset:29184
ds_read_b128 v[56:59], v35 offset:14336
ds_read_b128 v[188:191], v43 offset:8192
ds_read_b64_tr_b16 v[76:77], v44 offset:30720
ds_read_b64_tr_b16 v[78:79], v44 offset:31232
ds_read_b128 v[60:63], v35 offset:15360
s_waitcnt lgkmcnt(12)
v_mfma_f32_32x32x16_bf16 v[96:111], v[64:67], v[176:179], v[96:111]
v_mfma_f32_32x32x16_bf16 v[112:127], v[176:179], v[48:51], v[112:127]
s_cmp_lg_u32 s36, 0
s_cbranch_scc1 L_16
v_mfma_f32_4x4x4_16b_bf16 v[240:243], v[38:39], v[64:65], v[240:243]
v_mfma_f32_4x4x4_16b_bf16 v[244:247], v[38:39], v[66:67], v[244:247]
L_16:
s_waitcnt lgkmcnt(8)
v_mfma_f32_32x32x16_bf16 v[96:111], v[68:71], v[180:183], v[96:111]
v_mfma_f32_32x32x16_bf16 v[112:127], v[180:183], v[52:55], v[112:127]
s_cmp_lg_u32 s36, 1
s_cbranch_scc1 L_17
v_mfma_f32_4x4x4_16b_bf16 v[240:243], v[38:39], v[68:69], v[240:243]
v_mfma_f32_4x4x4_16b_bf16 v[244:247], v[38:39], v[70:71], v[244:247]
L_17:
s_waitcnt vmcnt(10) lgkmcnt(0)
s_barrier
ds_read_b128 v[192:195], v40 offset:32768
ds_read_b64_tr_b16 v[64:65], v44 offset:49152
ds_read_b64_tr_b16 v[66:67], v44 offset:49664
ds_read_b128 v[48:51], v35 offset:16384
ds_read_b128 v[196:199], v41 offset:32768
ds_read_b64_tr_b16 v[68:69], v44 offset:51200
ds_read_b64_tr_b16 v[70:71], v44 offset:51712
ds_read_b128 v[52:55], v35 offset:17408
s_waitcnt lgkmcnt(15)
v_mfma_f32_32x32x16_bf16 v[96:111], v[72:75], v[184:187], v[96:111]
v_mfma_f32_32x32x16_bf16 v[112:127], v[184:187], v[56:59], v[112:127]
s_cmp_lg_u32 s36, 2
s_cbranch_scc1 L_18
v_mfma_f32_4x4x4_16b_bf16 v[240:243], v[38:39], v[72:73], v[240:243]
v_mfma_f32_4x4x4_16b_bf16 v[244:247], v[38:39], v[74:75], v[244:247]
L_18:
s_add_u32 m0, s41, 73600
s_nop 0
buffer_load_dwordx4 v4, s[16:19], s63 offen offset:128 lds
s_add_u32 m0, s41, 81792
s_nop 0
buffer_load_dwordx4 v4, s[16:19], s64 offen offset:128 lds
s_waitcnt lgkmcnt(15)
v_mfma_f32_32x32x16_bf16 v[96:111], v[76:79], v[188:191], v[96:111]
v_mfma_f32_32x32x16_bf16 v[112:127], v[188:191], v[60:63], v[112:127]
s_cmp_lg_u32 s36, 3
s_cbranch_scc1 L_19
v_mfma_f32_4x4x4_16b_bf16 v[240:243], v[38:39], v[76:77], v[240:243]
v_mfma_f32_4x4x4_16b_bf16 v[244:247], v[38:39], v[78:79], v[244:247]
L_19:
s_add_u32 m0, s41, 89984
s_nop 0
buffer_load_dwordx4 v4, s[16:19], s65 offen offset:128 lds
ds_read_b128 v[200:203], v42 offset:32768
ds_read_b64_tr_b16 v[72:73], v44 offset:53248
ds_read_b64_tr_b16 v[74:75], v44 offset:53760
ds_read_b128 v[56:59], v35 offset:18432
ds_read_b128 v[204:207], v43 offset:32768
ds_read_b64_tr_b16 v[76:77], v44 offset:55296
ds_read_b64_tr_b16 v[78:79], v44 offset:55808
ds_read_b128 v[60:63], v35 offset:19456
s_waitcnt lgkmcnt(12)
v_mfma_f32_32x32x16_bf16 v[96:111], v[64:67], v[192:195], v[96:111]
v_mfma_f32_32x32x16_bf16 v[112:127], v[192:195], v[48:51], v[112:127]
s_cmp_lg_u32 s36, 0
s_cbranch_scc1 L_20
v_mfma_f32_4x4x4_16b_bf16 v[240:243], v[38:39], v[64:65], v[240:243]
v_mfma_f32_4x4x4_16b_bf16 v[244:247], v[38:39], v[66:67], v[244:247]
L_20:
s_waitcnt lgkmcnt(8)
v_mfma_f32_32x32x16_bf16 v[96:111], v[68:71], v[196:199], v[96:111]
v_mfma_f32_32x32x16_bf16 v[112:127], v[196:199], v[52:55], v[112:127]
s_cmp_lg_u32 s36, 1
s_cbranch_scc1 L_21
v_mfma_f32_4x4x4_16b_bf16 v[240:243], v[38:39], v[68:69], v[240:243]
v_mfma_f32_4x4x4_16b_bf16 v[244:247], v[38:39], v[70:71], v[244:247]
L_21:
s_waitcnt vmcnt(9) lgkmcnt(0)
s_barrier
ds_read_b128 v[208:211], v30 offset:0
ds_read_b64_tr_b16 v[64:65], v34 offset:16384
ds_read_b64_tr_b16 v[66:67], v34 offset:16896
ds_read_b128 v[48:51], v35 offset:20480
ds_read_b128 v[212:215], v31 offset:0
ds_read_b64_tr_b16 v[68:69], v34 offset:18432
ds_read_b64_tr_b16 v[70:71], v34 offset:18944
ds_read_b128 v[52:55], v35 offset:21504
s_waitcnt lgkmcnt(15)
v_mfma_f32_32x32x16_bf16 v[96:111], v[72:75], v[200:203], v[96:111]
v_mfma_f32_32x32x16_bf16 v[112:127], v[200:203], v[56:59], v[112:127]
s_cmp_lg_u32 s36, 2
s_cbranch_scc1 L_22
v_mfma_f32_4x4x4_16b_bf16 v[240:243], v[38:39], v[72:73], v[240:243]
v_mfma_f32_4x4x4_16b_bf16 v[244:247], v[38:39], v[74:75], v[244:247]
L_22:
s_add_u32 m0, s41, 98176
s_nop 0
buffer_load_dwordx4 v4, s[16:19], s66 offen offset:128 lds
s_waitcnt lgkmcnt(15)
v_mfma_f32_32x32x16_bf16 v[96:111], v[76:79], v[204:207], v[96:111]
v_mfma_f32_32x32x16_bf16 v[112:127], v[204:207], v[60:63], v[112:127]
s_cmp_lg_u32 s36, 3
s_cbranch_scc1 L_23
v_mfma_f32_4x4x4_16b_bf16 v[240:243], v[38:39], v[76:77], v[240:243]
v_mfma_f32_4x4x4_16b_bf16 v[244:247], v[38:39], v[78:79], v[244:247]
L_23:
ds_read_b128 v[216:219], v32 offset:0
ds_read_b64_tr_b16 v[72:73], v34 offset:20480
ds_read_b64_tr_b16 v[74:75], v34 offset:20992
ds_read_b128 v[56:59], v35 offset:22528
ds_read_b128 v[220:223], v33 offset:0
ds_read_b64_tr_b16 v[76:77], v34 offset:22528
ds_read_b64_tr_b16 v[78:79], v34 offset:23040
ds_read_b128 v[60:63], v35 offset:23552
s_waitcnt lgkmcnt(12)
v_mfma_f32_32x32x16_bf16 v[96:111], v[64:67], v[208:211], v[96:111]
v_mfma_f32_32x32x16_bf16 v[112:127], v[208:211], v[48:51], v[112:127]
s_cmp_lg_u32 s36, 0
s_cbranch_scc1 L_24
v_mfma_f32_4x4x4_16b_bf16 v[240:243], v[38:39], v[64:65], v[240:243]
v_mfma_f32_4x4x4_16b_bf16 v[244:247], v[38:39], v[66:67], v[244:247]
L_24:
s_waitcnt lgkmcnt(8)
v_mfma_f32_32x32x16_bf16 v[96:111], v[68:71], v[212:215], v[96:111]
v_mfma_f32_32x32x16_bf16 v[112:127], v[212:215], v[52:55], v[112:127]
s_cmp_lg_u32 s36, 1
s_cbranch_scc1 L_25
v_mfma_f32_4x4x4_16b_bf16 v[240:243], v[38:39], v[68:69], v[240:243]
v_mfma_f32_4x4x4_16b_bf16 v[244:247], v[38:39], v[70:71], v[244:247]
L_25:
s_waitcnt vmcnt(7) lgkmcnt(0)
s_barrier
ds_read_b128 v[224:227], v30 offset:24576
ds_read_b64_tr_b16 v[64:65], v34 offset:40960
ds_read_b64_tr_b16 v[66:67], v34 offset:41472
ds_read_b128 v[48:51], v35 offset:24576
ds_read_b128 v[228:231], v31 offset:24576
ds_read_b64_tr_b16 v[68:69], v34 offset:43008
ds_read_b64_tr_b16 v[70:71], v34 offset:43520
ds_read_b128 v[52:55], v35 offset:25600
s_waitcnt lgkmcnt(15)
v_mfma_f32_32x32x16_bf16 v[96:111], v[72:75], v[216:219], v[96:111]
v_mfma_f32_32x32x16_bf16 v[112:127], v[216:219], v[56:59], v[112:127]
s_cmp_lg_u32 s36, 2
s_cbranch_scc1 L_26
v_mfma_f32_4x4x4_16b_bf16 v[240:243], v[38:39], v[72:73], v[240:243]
v_mfma_f32_4x4x4_16b_bf16 v[244:247], v[38:39], v[74:75], v[244:247]
L_26:
s_waitcnt lgkmcnt(15)
v_mfma_f32_32x32x16_bf16 v[96:111], v[76:79], v[220:223], v[96:111]
v_mfma_f32_32x32x16_bf16 v[112:127], v[220:223], v[60:63], v[112:127]
s_cmp_lg_u32 s36, 3
s_cbranch_scc1 L_27
v_mfma_f32_4x4x4_16b_bf16 v[240:243], v[38:39], v[76:77], v[240:243]
v_mfma_f32_4x4x4_16b_bf16 v[244:247], v[38:39], v[78:79], v[244:247]
L_27:
ds_read_b128 v[232:235], v32 offset:24576
ds_read_b64_tr_b16 v[72:73], v34 offset:45056
ds_read_b64_tr_b16 v[74:75], v34 offset:45568
ds_read_b128 v[56:59], v35 offset:26624
ds_read_b128 v[236:239], v33 offset:24576
ds_read_b64_tr_b16 v[76:77], v34 offset:47104
ds_read_b64_tr_b16 v[78:79], v34 offset:47616
ds_read_b128 v[60:63], v35 offset:27648
s_waitcnt lgkmcnt(12)
v_mfma_f32_32x32x16_bf16 v[96:111], v[64:67], v[224:227], v[96:111]
v_mfma_f32_32x32x16_bf16 v[112:127], v[224:227], v[48:51], v[112:127]
s_cmp_lg_u32 s36, 0
s_cbranch_scc1 L_28
v_mfma_f32_4x4x4_16b_bf16 v[240:243], v[38:39], v[64:65], v[240:243]
v_mfma_f32_4x4x4_16b_bf16 v[244:247], v[38:39], v[66:67], v[244:247]
L_28:
s_waitcnt lgkmcnt(8)
v_mfma_f32_32x32x16_bf16 v[96:111], v[68:71], v[228:231], v[96:111]
v_mfma_f32_32x32x16_bf16 v[112:127], v[228:231], v[52:55], v[112:127]
s_cmp_lg_u32 s36, 1
s_cbranch_scc1 L_29
v_mfma_f32_4x4x4_16b_bf16 v[240:243], v[38:39], v[68:69], v[240:243]
v_mfma_f32_4x4x4_16b_bf16 v[244:247], v[38:39], v[70:71], v[244:247]
L_29:
s_waitcnt lgkmcnt(4)
v_mfma_f32_32x32x16_bf16 v[96:111], v[72:75], v[232:235], v[96:111]
v_mfma_f32_32x32x16_bf16 v[112:127], v[232:235], v[56:59], v[112:127]
s_cmp_lg_u32 s36, 2
s_cbranch_scc1 L_30
v_mfma_f32_4x4x4_16b_bf16 v[240:243], v[38:39], v[72:73], v[240:243]
v_mfma_f32_4x4x4_16b_bf16 v[244:247], v[38:39], v[74:75], v[244:247]
L_30:
s_waitcnt lgkmcnt(0)
v_mfma_f32_32x32x16_bf16 v[96:111], v[76:79], v[236:239], v[96:111]
v_mfma_f32_32x32x16_bf16 v[112:127], v[236:239], v[60:63], v[112:127]
s_cmp_lg_u32 s36, 3
s_cbranch_scc1 L_31
v_mfma_f32_4x4x4_16b_bf16 v[240:243], v[38:39], v[76:77], v[240:243]
v_mfma_f32_4x4x4_16b_bf16 v[244:247], v[38:39], v[78:79], v[244:247]
L_31:
s_lshl_b32 s38, s32, 8
s_add_u32 s38, s38, 155648
v_add_u32 v10, s38, v28
s_nop 2
v_add_f32 v12, v240, v244
ds_write_b32 v10, v12
s_waitcnt vmcnt(0) lgkmcnt(0)
s_barrier
v_lshlrev_b32 v10, 2, v5
s_lshl_b32 s38, s36, 9
s_add_u32 s38, s38, 153600
v_add_u32 v10, s38, v10
ds_read2_b32 v[12:13], v10 offset0:0 offset1:32
ds_read2_b32 v[14:15], v10 offset0:64 offset1:96
s_lshl_b32 s38, s37, 10
s_add_u32 s38, s38, 155648
v_add_u32 v11, s38, v28
ds_read2st64_b32 v[16:17], v11 offset0:0 offset1:1
ds_read2st64_b32 v[18:19], v11 offset0:2 offset1:3
v_cmp_gt_u32 vcc, 32, v0
v_mov_b32 v22, 0
v_mov_b32 v23, 0
v_mov_b32 v25, v8
v_mov_b32 v26, 0
v_mov_b32 v27, 0
s_waitcnt lgkmcnt(2)
v_add_f32 v12, v12, v13
v_add_f32 v14, v14, v15
v_mul_f32 v12, 0x3b124925, v12
v_mul_f32 v14, 0x3b124925, v14
v_fma_f32 v14, -v12, v12, v14
v_max_f32 v14, 0, v14
v_cvt_pk_bf16_f32 v14, v14, v14
v_and_b32 v14, 0xffff0000, v14
v_add_f32 v14, 0x3727c5ac, v14
v_cvt_pk_bf16_f32 v14, v14, v14
v_and_b32 v14, 0xffff0000, v14
v_sqrt_f32 v14, v14
v_cvt_pk_bf16_f32 v20, -v12, -v12
v_cvt_pk_bf16_f32 v14, v14, v14
v_and_b32 v45, 0xffff0000, v14
v_rcp_f32 v46, v45
v_lshrrev_b32 v21, 16, v45
v_cndmask_b32 v21, 0, v21, vcc
v_mul_f32 v36, 0xc0135761, v46
v_mul_f32 v37, v46, v46
v_mul_f32 v37, v37, v46
v_mul_f32 v37, 0xbdd2d3e8, v37
s_waitcnt lgkmcnt(0)
v_add_f32 v16, v16, v17
v_add_f32 v18, v18, v19
v_add_f32 v16, v16, v18
v_cvt_pk_bf16_f32 v17, v16, v16
v_and_b32 v17, 0xffff0000, v17
v_sub_f32 v18, v16, v17
v_cvt_pk_bf16_f32 v24, v17, v18
s_nop 1
v_mfma_f32_32x32x16_bf16 v[96:111], v[24:27], v[20:23], v[96:111]
v_mul_f32 v13, 0x36124925, v46
s_lshl_b32 s38, s36, 7
s_add_u32 s38, s38, 159744
v_lshl_add_u32 v10, v5, 2, s38
ds_write_b32 v10, v13
v_lshl_add_u32 v10, v6, 4, s38
ds_read_b128 v[48:51], v10
ds_read_b128 v[52:55], v10 offset:32
ds_read_b128 v[56:59], v10 offset:64
ds_read_b128 v[60:63], v10 offset:96
v_or_b32 v12, s35, v0
v_cmp_eq_u32 vcc, 0, v12
v_mov_b32 v12, 0x43e0
v_mov_b32 v17, 0
v_cndmask_b32 v16, 0, v12, vcc
v_mov_b32 v18, 0
v_mov_b32 v19, 0
v_mul_u32_u24 v10, 272, v5
v_lshl_add_u32 v10, v6, 6, v10
v_mfma_f32_32x32x16_bf16 v[112:127], v[20:23], v[16:19], v[112:127]
s_nop 0
s_lshl_b32 s38, s36, 2
s_add_u32 s38, s38, 106496
v_add_u32 v10, s38, v10
s_nop 7
s_waitcnt lgkmcnt(0)
v_mul_f32 v112, v112, v48
v_mul_f32 v113, v113, v49
v_mul_f32 v114, v114, v50
v_mul_f32 v115, v115, v51
v_mul_f32 v116, v116, v52
v_mul_f32 v117, v117, v53
v_mul_f32 v118, v118, v54
v_mul_f32 v119, v119, v55
v_mul_f32 v120, v120, v56
v_mul_f32 v121, v121, v57
v_mul_f32 v122, v122, v58
v_mul_f32 v123, v123, v59
v_mul_f32 v124, v124, v60
v_mul_f32 v125, v125, v61
v_mul_f32 v126, v126, v62
v_mul_f32 v127, v127, v63
v_cvt_pk_bf16_f32 v12, v112, v113
v_cvt_pk_bf16_f32 v13, v114, v115
v_cvt_pk_bf16_f32 v14, v116, v117
v_cvt_pk_bf16_f32 v15, v118, v119
v_cvt_pk_bf16_f32 v16, v120, v121
v_cvt_pk_bf16_f32 v17, v122, v123
v_cvt_pk_bf16_f32 v18, v124, v125
v_cvt_pk_bf16_f32 v19, v126, v127
s_nop 1
v_mfma_f32_32x32x16_bf16 v[48:63], v[12:15], v[80:83], 0
v_mfma_f32_32x32x16_bf16 v[112:127], v[12:15], v[88:91], 0
v_mfma_f32_32x32x16_bf16 v[48:63], v[16:19], v[84:87], v[48:63]
v_mfma_f32_32x32x16_bf16 v[112:127], v[16:19], v[92:95], v[112:127]
s_nop 7
s_nop 3
v_add_f32 v240, v48, v120
v_sub_f32 v12, v56, v112
v_add_f32 v241, v49, v121
v_sub_f32 v13, v57, v113
v_add_f32 v242, v50, v122
v_sub_f32 v14, v58, v114
v_add_f32 v243, v51, v123
v_sub_f32 v15, v59, v115
v_add_f32 v244, v52, v124
v_sub_f32 v16, v60, v116
v_add_f32 v245, v53, v125
v_sub_f32 v17, v61, v117
v_add_f32 v246, v54, v126
v_sub_f32 v18, v62, v118
v_add_f32 v247, v55, v127
v_sub_f32 v19, v63, v119
s_cmp_lg_u32 s35, 0
s_cbranch_scc1 NOSPEC_32
s_mov_b64 exec, 0xffffffff
v_mul_f32 v240, 0.5, v48
v_mul_f32 v12, -0.5, v112
v_mul_f32 v1, 0.5, v56
v_mul_f32 v7, -0.5, v120
v_cvt_pk_bf16_f32 v1, v1, v7
ds_write_b32 v10, v1 offset:256
s_mov_b64 exec, -1
NOSPEC_32:
v_cvt_pk_bf16_f32 v240, v240, v12
ds_write_b32 v10, v240 offset:0
v_cvt_pk_bf16_f32 v241, v241, v13
ds_write_b32 v10, v241 offset:16
v_cvt_pk_bf16_f32 v242, v242, v14
ds_write_b32 v10, v242 offset:32
v_cvt_pk_bf16_f32 v243, v243, v15
ds_write_b32 v10, v243 offset:48
v_cvt_pk_bf16_f32 v244, v244, v16
ds_write_b32 v10, v244 offset:128
v_cvt_pk_bf16_f32 v245, v245, v17
ds_write_b32 v10, v245 offset:144
v_cvt_pk_bf16_f32 v246, v246, v18
ds_write_b32 v10, v246 offset:160
v_cvt_pk_bf16_f32 v247, v247, v19
ds_write_b32 v10, v247 offset:176
v_mov_b32 v12, 160256
v_mov_b32 v13, 1
s_mov_b64 exec, 1
s_waitcnt lgkmcnt(0)
ds_add_u32 v12, v13
s_mov_b64 exec, -1
s_waitcnt lgkmcnt(0)
s_and_b32 s38, s42, 1
s_mul_i32 s38, s38, 7
s_sub_u32 s38, s35, s38
s_mul_i32 s38, s38, 229376
s_add_u32 s38, s38, 7340032
s_mul_i32 s67, s32, 7
s_lshr_b32 s52, s67, 2
s_lshl_b32 s52, s52, 2
s_add_u32 s52, s52, s67
s_lshl_b32 s52, s52, 10
s_add_u32 s52, s52, s38
s_add_u32 s67, s67, 1
s_lshr_b32 s53, s67, 2
s_lshl_b32 s53, s53, 2
s_add_u32 s53, s53, s67
s_lshl_b32 s53, s53, 10
s_add_u32 s53, s53, s38
s_add_u32 s67, s67, 1
s_lshr_b32 s54, s67, 2
s_lshl_b32 s54, s54, 2
s_add_u32 s54, s54, s67
s_lshl_b32 s54, s54, 10
s_add_u32 s54, s54, s38
s_add_u32 s67, s67, 1
s_lshr_b32 s55, s67, 2
s_lshl_b32 s55, s55, 2
s_add_u32 s55, s55, s67
s_lshl_b32 s55, s55, 10
s_add_u32 s55, s55, s38
s_add_u32 s67, s67, 1
s_lshr_b32 s56, s67, 2
s_lshl_b32 s56, s56, 2
s_add_u32 s56, s56, s67
s_lshl_b32 s56, s56, 10
s_add_u32 s56, s56, s38
s_add_u32 s67, s67, 1
s_lshr_b32 s57, s67, 2
s_lshl_b32 s57, s57, 2
s_add_u32 s57, s57, s67
s_lshl_b32 s57, s57, 10
s_add_u32 s57, s57, s38
s_add_u32 s67, s67, 1
s_lshr_b32 s58, s67, 2
s_lshl_b32 s58, s58, 2
s_add_u32 s58, s58, s67
s_lshl_b32 s58, s58, 10
s_add_u32 s58, s58, s38
s_add_u32 s67, s67, 1
ds_read_b64_tr_b16 v[64:65], v34 offset:49152
ds_read_b64_tr_b16 v[66:67], v34 offset:49664
ds_read_b64_tr_b16 v[68:69], v34 offset:51200
ds_read_b64_tr_b16 v[70:71], v34 offset:51712
ds_read_b64_tr_b16 v[72:73], v34 offset:53248
ds_read_b64_tr_b16 v[74:75], v34 offset:53760
ds_read_b64_tr_b16 v[76:77], v34 offset:55296
ds_read_b64_tr_b16 v[78:79], v34 offset:55808
s_waitcnt lgkmcnt(6)
v_mfma_f32_32x32x16_bf16 v[80:95], v[64:67], v[128:131], 0
s_cmp_lg_u32 s36, 0
s_cbranch_scc1 L_33
v_mfma_f32_4x4x4_16b_bf16 v[112:115], v[38:39], v[64:65], 0
v_mfma_f32_4x4x4_16b_bf16 v[116:119], v[38:39], v[66:67], 0
L_33:
v_mov_b32 v14, 160260
WSPIN_34:
ds_read_b32 v15, v14
s_waitcnt lgkmcnt(0)
v_readfirstlane_b32 s38, v15
s_cmp_eq_u32 s38, 0
s_cbranch_scc1 WSPIN_34
ds_read_b64_tr_b16 v[64:65], v34 offset:57344
ds_read_b64_tr_b16 v[66:67], v34 offset:57856
s_waitcnt lgkmcnt(6)
v_mfma_f32_32x32x16_bf16 v[80:95], v[68:71], v[132:135], v[80:95]
s_cmp_lg_u32 s36, 1
s_cbranch_scc1 L_35
v_mfma_f32_4x4x4_16b_bf16 v[112:115], v[38:39], v[68:69], 0
v_mfma_f32_4x4x4_16b_bf16 v[116:119], v[38:39], v[70:71], 0
L_35:
buffer_load_dwordx4 v[128:131], v29, s[20:23], s52 offen
ds_read_b64_tr_b16 v[68:69], v34 offset:59392
ds_read_b64_tr_b16 v[70:71], v34 offset:59904
s_waitcnt lgkmcnt(6)
v_mfma_f32_32x32x16_bf16 v[80:95], v[72:75], v[136:139], v[80:95]
s_cmp_lg_u32 s36, 2
s_cbranch_scc1 L_36
v_mfma_f32_4x4x4_16b_bf16 v[112:115], v[38:39], v[72:73], 0
v_mfma_f32_4x4x4_16b_bf16 v[116:119], v[38:39], v[74:75], 0
L_36:
v_mul_f32 v240, v96, v96
v_mul_f32 v241, v97, v97
v_mul_f32 v242, v98, v98
v_mul_f32 v243, v99, v99
v_mul_f32 v244, v100, v100
v_mul_f32 v245, v101, v101
v_mul_f32 v246, v102, v102
v_mul_f32 v247, v103, v103
ds_read_b64_tr_b16 v[72:73], v34 offset:61440
ds_read_b64_tr_b16 v[74:75], v34 offset:61952
s_waitcnt lgkmcnt(6)
v_mfma_f32_32x32x16_bf16 v[80:95], v[76:79], v[140:143], v[80:95]
s_cmp_lg_u32 s36, 3
s_cbranch_scc1 L_37
v_mfma_f32_4x4x4_16b_bf16 v[112:115], v[38:39], v[76:77], 0
v_mfma_f32_4x4x4_16b_bf16 v[116:119], v[38:39], v[78:79], 0
L_37:
s_add_u32 s67, s52, 114688
buffer_load_dwordx4 v[132:135], v29, s[20:23], s67 offen
v_fma_f32 v240, v240, v37, v36
v_fma_f32 v241, v241, v37, v36
v_fma_f32 v242, v242, v37, v36
v_fma_f32 v243, v243, v37, v36
v_fma_f32 v244, v244, v37, v36
v_fma_f32 v245, v245, v37, v36
v_fma_f32 v246, v246, v37, v36
v_fma_f32 v247, v247, v37, v36
ds_read_b64_tr_b16 v[76:77], v34 offset:63488
ds_read_b64_tr_b16 v[78:79], v34 offset:64000
s_waitcnt lgkmcnt(6)
v_mfma_f32_32x32x16_bf16 v[80:95], v[64:67], v[144:147], v[80:95]
s_cmp_lg_u32 s36, 0
s_cbranch_scc1 L_38
v_mfma_f32_4x4x4_16b_bf16 v[112:115], v[38:39], v[64:65], v[112:115]
v_mfma_f32_4x4x4_16b_bf16 v[116:119], v[38:39], v[66:67], v[116:119]
L_38:
buffer_load_dwordx4 v[136:139], v29, s[20:23], s53 offen
v_mul_f32 v240, v96, v240
v_mul_f32 v241, v97, v241
v_mul_f32 v242, v98, v242
v_mul_f32 v243, v99, v243
v_mul_f32 v244, v100, v244
v_mul_f32 v245, v101, v245
v_mul_f32 v246, v102, v246
v_mul_f32 v247, v103, v247
ds_read_b64_tr_b16 v[64:65], v44 offset:0
ds_read_b64_tr_b16 v[66:67], v44 offset:512
s_waitcnt lgkmcnt(6)
v_mfma_f32_32x32x16_bf16 v[80:95], v[68:71], v[148:151], v[80:95]
s_cmp_lg_u32 s36, 1
s_cbranch_scc1 L_39
v_mfma_f32_4x4x4_16b_bf16 v[112:115], v[38:39], v[68:69], v[112:115]
v_mfma_f32_4x4x4_16b_bf16 v[116:119], v[38:39], v[70:71], v[116:119]
L_39:
v_exp_f32 v240, v240
v_exp_f32 v241, v241
v_exp_f32 v242, v242
v_exp_f32 v243, v243
ds_read_b64_tr_b16 v[68:69], v44 offset:2048
ds_read_b64_tr_b16 v[70:71], v44 offset:2560
s_waitcnt lgkmcnt(6)
v_mfma_f32_32x32x16_bf16 v[80:95], v[72:75], v[152:155], v[80:95]
s_cmp_lg_u32 s36, 2
s_cbranch_scc1 L_40
v_mfma_f32_4x4x4_16b_bf16 v[112:115], v[38:39], v[72:73], v[112:115]
v_mfma_f32_4x4x4_16b_bf16 v[116:119], v[38:39], v[74:75], v[116:119]
L_40:
s_add_u32 s67, s53, 114688
buffer_load_dwordx4 v[140:143], v29, s[20:23], s67 offen
v_exp_f32 v244, v244
v_exp_f32 v245, v245
v_exp_f32 v246, v246
v_exp_f32 v247, v247
ds_read_b64_tr_b16 v[72:73], v44 offset:4096
ds_read_b64_tr_b16 v[74:75], v44 offset:4608
s_waitcnt lgkmcnt(6)
v_mfma_f32_32x32x16_bf16 v[80:95], v[76:79], v[156:159], v[80:95]
s_cmp_lg_u32 s36, 3
s_cbranch_scc1 L_41
v_mfma_f32_4x4x4_16b_bf16 v[112:115], v[38:39], v[76:77], v[112:115]
v_mfma_f32_4x4x4_16b_bf16 v[116:119], v[38:39], v[78:79], v[116:119]
L_41:
buffer_load_dwordx4 v[144:147], v29, s[20:23], s54 offen
v_fma_f32 v240, v240, v45, v45
v_fma_f32 v241, v241, v45, v45
v_fma_f32 v242, v242, v45, v45
v_fma_f32 v243, v243, v45, v45
v_fma_f32 v244, v244, v45, v45
v_fma_f32 v245, v245, v45, v45
v_fma_f32 v246, v246, v45, v45
v_fma_f32 v247, v247, v45, v45
ds_read_b64_tr_b16 v[76:77], v44 offset:6144
ds_read_b64_tr_b16 v[78:79], v44 offset:6656
s_waitcnt lgkmcnt(6)
v_mfma_f32_32x32x16_bf16 v[80:95], v[64:67], v[160:163], v[80:95]
s_cmp_lg_u32 s36, 0
s_cbranch_scc1 L_42
v_mfma_f32_4x4x4_16b_bf16 v[112:115], v[38:39], v[64:65], v[112:115]
v_mfma_f32_4x4x4_16b_bf16 v[116:119], v[38:39], v[66:67], v[116:119]
L_42:
v_rcp_f32 v240, v240
v_rcp_f32 v241, v241
v_rcp_f32 v242, v242
v_rcp_f32 v243, v243
ds_read_b64_tr_b16 v[64:65], v44 offset:8192
ds_read_b64_tr_b16 v[66:67], v44 offset:8704
s_waitcnt lgkmcnt(6)
v_mfma_f32_32x32x16_bf16 v[80:95], v[68:71], v[164:167], v[80:95]
s_cmp_lg_u32 s36, 1
s_cbranch_scc1 L_43
v_mfma_f32_4x4x4_16b_bf16 v[112:115], v[38:39], v[68:69], v[112:115]
v_mfma_f32_4x4x4_16b_bf16 v[116:119], v[38:39], v[70:71], v[116:119]
L_43:
s_add_u32 s67, s54, 114688
buffer_load_dwordx4 v[148:151], v29, s[20:23], s67 offen
v_rcp_f32 v244, v244
v_rcp_f32 v245, v245
v_rcp_f32 v246, v246
v_rcp_f32 v247, v247
ds_read_b64_tr_b16 v[68:69], v44 offset:10240
ds_read_b64_tr_b16 v[70:71], v44 offset:10752
s_waitcnt lgkmcnt(6)
v_mfma_f32_32x32x16_bf16 v[80:95], v[72:75], v[168:171], v[80:95]
s_cmp_lg_u32 s36, 2
s_cbranch_scc1 L_44
v_mfma_f32_4x4x4_16b_bf16 v[112:115], v[38:39], v[72:73], v[112:115]
v_mfma_f32_4x4x4_16b_bf16 v[116:119], v[38:39], v[74:75], v[116:119]
L_44:
buffer_load_dwordx4 v[152:155], v29, s[20:23], s55 offen
v_mul_f32 v240, v96, v240
v_mul_f32 v241, v97, v241
v_mul_f32 v242, v98, v242
v_mul_f32 v243, v99, v243
v_mul_f32 v244, v100, v244
v_mul_f32 v245, v101, v245
v_mul_f32 v246, v102, v246
v_mul_f32 v247, v103, v247
ds_read_b64_tr_b16 v[72:73], v44 offset:12288
ds_read_b64_tr_b16 v[74:75], v44 offset:12800
s_waitcnt lgkmcnt(6)
v_mfma_f32_32x32x16_bf16 v[80:95], v[76:79], v[172:175], v[80:95]
s_cmp_lg_u32 s36, 3
s_cbranch_scc1 L_45
v_mfma_f32_4x4x4_16b_bf16 v[112:115], v[38:39], v[76:77], v[112:115]
v_mfma_f32_4x4x4_16b_bf16 v[116:119], v[38:39], v[78:79], v[116:119]
L_45:
v_cvt_pk_bf16_f32 v248, v240, v241
v_cvt_pk_bf16_f32 v249, v242, v243
v_cvt_pk_bf16_f32 v250, v244, v245
v_cvt_pk_bf16_f32 v251, v246, v247
buffer_store_dwordx4 v[248:251], v29, s[20:23], s45 offen offset:0 sc1
v_mul_f32 v240, v104, v104
v_mul_f32 v241, v105, v105
v_mul_f32 v242, v106, v106
ds_read_b64_tr_b16 v[76:77], v44 offset:14336
ds_read_b64_tr_b16 v[78:79], v44 offset:14848
s_waitcnt lgkmcnt(6)
v_mfma_f32_32x32x16_bf16 v[80:95], v[64:67], v[176:179], v[80:95]
s_cmp_lg_u32 s36, 0
s_cbranch_scc1 L_46
v_mfma_f32_4x4x4_16b_bf16 v[112:115], v[38:39], v[64:65], v[112:115]
v_mfma_f32_4x4x4_16b_bf16 v[116:119], v[38:39], v[66:67], v[116:119]
L_46:
s_add_u32 s67, s55, 114688
buffer_load_dwordx4 v[156:159], v29, s[20:23], s67 offen
v_mul_f32 v243, v107, v107
v_mul_f32 v244, v108, v108
v_mul_f32 v245, v109, v109
v_mul_f32 v246, v110, v110
v_mul_f32 v247, v111, v111
v_fma_f32 v240, v240, v37, v36
v_fma_f32 v241, v241, v37, v36
v_fma_f32 v242, v242, v37, v36
ds_read_b64_tr_b16 v[64:65], v44 offset:16384
ds_read_b64_tr_b16 v[66:67], v44 offset:16896
s_waitcnt lgkmcnt(6)
v_mfma_f32_32x32x16_bf16 v[80:95], v[68:71], v[180:183], v[80:95]
s_cmp_lg_u32 s36, 1
s_cbranch_scc1 L_47
v_mfma_f32_4x4x4_16b_bf16 v[112:115], v[38:39], v[68:69], v[112:115]
v_mfma_f32_4x4x4_16b_bf16 v[116:119], v[38:39], v[70:71], v[116:119]
L_47:
buffer_load_dwordx4 v[160:163], v29, s[20:23], s56 offen
v_fma_f32 v243, v243, v37, v36
v_fma_f32 v244, v244, v37, v36
v_fma_f32 v245, v245, v37, v36
v_fma_f32 v246, v246, v37, v36
v_fma_f32 v247, v247, v37, v36
v_mul_f32 v240, v104, v240
v_mul_f32 v241, v105, v241
v_mul_f32 v242, v106, v242
ds_read_b64_tr_b16 v[68:69], v44 offset:18432
ds_read_b64_tr_b16 v[70:71], v44 offset:18944
s_waitcnt lgkmcnt(6)
v_mfma_f32_32x32x16_bf16 v[80:95], v[72:75], v[184:187], v[80:95]
s_cmp_lg_u32 s36, 2
s_cbranch_scc1 L_48
v_mfma_f32_4x4x4_16b_bf16 v[112:115], v[38:39], v[72:73], v[112:115]
v_mfma_f32_4x4x4_16b_bf16 v[116:119], v[38:39], v[74:75], v[116:119]
L_48:
v_mul_f32 v243, v107, v243
v_mul_f32 v244, v108, v244
v_mul_f32 v245, v109, v245
v_mul_f32 v246, v110, v246
v_mul_f32 v247, v111, v247
v_exp_f32 v240, v240
v_exp_f32 v241, v241
ds_read_b64_tr_b16 v[72:73], v44 offset:20480
ds_read_b64_tr_b16 v[74:75], v44 offset:20992
s_waitcnt lgkmcnt(6)
v_mfma_f32_32x32x16_bf16 v[80:95], v[76:79], v[188:191], v[80:95]
s_cmp_lg_u32 s36, 3
s_cbranch_scc1 L_49
v_mfma_f32_4x4x4_16b_bf16 v[112:115], v[38:39], v[76:77], v[112:115]
v_mfma_f32_4x4x4_16b_bf16 v[116:119], v[38:39], v[78:79], v[116:119]
L_49:
s_add_u32 s67, s56, 114688
buffer_load_dwordx4 v[164:167], v29, s[20:23], s67 offen
v_exp_f32 v242, v242
v_exp_f32 v243, v243
v_exp_f32 v244, v244
v_exp_f32 v245, v245
ds_read_b64_tr_b16 v[76:77], v44 offset:22528
ds_read_b64_tr_b16 v[78:79], v44 offset:23040
s_waitcnt lgkmcnt(6)
v_mfma_f32_32x32x16_bf16 v[80:95], v[64:67], v[192:195], v[80:95]
s_cmp_lg_u32 s36, 0
s_cbranch_scc1 L_50
v_mfma_f32_4x4x4_16b_bf16 v[112:115], v[38:39], v[64:65], v[112:115]
v_mfma_f32_4x4x4_16b_bf16 v[116:119], v[38:39], v[66:67], v[116:119]
L_50:
v_exp_f32 v246, v246
v_exp_f32 v247, v247
v_fma_f32 v240, v240, v45, v45
v_fma_f32 v241, v241, v45, v45
v_fma_f32 v242, v242, v45, v45
v_fma_f32 v243, v243, v45, v45
ds_read_b64_tr_b16 v[64:65], v44 offset:24576
ds_read_b64_tr_b16 v[66:67], v44 offset:25088
s_waitcnt lgkmcnt(6)
v_mfma_f32_32x32x16_bf16 v[80:95], v[68:71], v[196:199], v[80:95]
s_cmp_lg_u32 s36, 1
s_cbranch_scc1 L_51
v_mfma_f32_4x4x4_16b_bf16 v[112:115], v[38:39], v[68:69], v[112:115]
v_mfma_f32_4x4x4_16b_bf16 v[116:119], v[38:39], v[70:71], v[116:119]
L_51:
buffer_load_dwordx4 v[168:171], v29, s[20:23], s57 offen
v_fma_f32 v244, v244, v45, v45
v_fma_f32 v245, v245, v45, v45
v_fma_f32 v246, v246, v45, v45
v_fma_f32 v247, v247, v45, v45
v_rcp_f32 v240, v240
v_rcp_f32 v241, v241
ds_read_b64_tr_b16 v[68:69], v44 offset:26624
ds_read_b64_tr_b16 v[70:71], v44 offset:27136
s_waitcnt lgkmcnt(6)
v_mfma_f32_32x32x16_bf16 v[80:95], v[72:75], v[200:203], v[80:95]
s_cmp_lg_u32 s36, 2
s_cbranch_scc1 L_52
v_mfma_f32_4x4x4_16b_bf16 v[112:115], v[38:39], v[72:73], v[112:115]
v_mfma_f32_4x4x4_16b_bf16 v[116:119], v[38:39], v[74:75], v[116:119]
L_52:
s_add_u32 s67, s57, 114688
buffer_load_dwordx4 v[172:175], v29, s[20:23], s67 offen
v_rcp_f32 v242, v242
v_rcp_f32 v243, v243
v_rcp_f32 v244, v244
v_rcp_f32 v245, v245
ds_read_b64_tr_b16 v[72:73], v44 offset:28672
ds_read_b64_tr_b16 v[74:75], v44 offset:29184
s_waitcnt lgkmcnt(6)
v_mfma_f32_32x32x16_bf16 v[80:95], v[76:79], v[204:207], v[80:95]
s_cmp_lg_u32 s36, 3
s_cbranch_scc1 L_53
v_mfma_f32_4x4x4_16b_bf16 v[112:115], v[38:39], v[76:77], v[112:115]
v_mfma_f32_4x4x4_16b_bf16 v[116:119], v[38:39], v[78:79], v[116:119]
L_53:
v_rcp_f32 v246, v246
v_rcp_f32 v247, v247
v_mul_f32 v240, v104, v240
v_mul_f32 v241, v105, v241
v_mul_f32 v242, v106, v242
v_mul_f32 v243, v107, v243
ds_read_b64_tr_b16 v[76:77], v44 offset:30720
ds_read_b64_tr_b16 v[78:79], v44 offset:31232
s_waitcnt lgkmcnt(6)
v_mfma_f32_32x32x16_bf16 v[80:95], v[64:67], v[208:211], v[80:95]
s_cmp_lg_u32 s36, 0
s_cbranch_scc1 L_54
v_mfma_f32_4x4x4_16b_bf16 v[112:115], v[38:39], v[64:65], v[112:115]
v_mfma_f32_4x4x4_16b_bf16 v[116:119], v[38:39], v[66:67], v[116:119]
L_54:
buffer_load_dwordx4 v[176:179], v29, s[20:23], s58 offen
v_mul_f32 v244, v108, v244
v_mul_f32 v245, v109, v245
v_mul_f32 v246, v110, v246
v_mul_f32 v247, v111, v247
v_cvt_pk_bf16_f32 v252, v240, v241
v_cvt_pk_bf16_f32 v253, v242, v243
v_cvt_pk_bf16_f32 v254, v244, v245
v_cvt_pk_bf16_f32 v255, v246, v247
ds_read_b64_tr_b16 v[64:65], v44 offset:32768
ds_read_b64_tr_b16 v[66:67], v44 offset:33280
s_waitcnt lgkmcnt(6)
v_mfma_f32_32x32x16_bf16 v[80:95], v[68:71], v[212:215], v[80:95]
s_cmp_lg_u32 s36, 1
s_cbranch_scc1 L_55
v_mfma_f32_4x4x4_16b_bf16 v[112:115], v[38:39], v[68:69], v[112:115]
v_mfma_f32_4x4x4_16b_bf16 v[116:119], v[38:39], v[70:71], v[116:119]
L_55:
s_add_u32 s67, s58, 114688
buffer_load_dwordx4 v[180:183], v29, s[20:23], s67 offen
buffer_store_dwordx4 v[252:255], v29, s[20:23], s45 offen offset:1024 sc1
ds_read_b64_tr_b16 v[68:69], v44 offset:34816
ds_read_b64_tr_b16 v[70:71], v44 offset:35328
s_waitcnt lgkmcnt(6)
v_mfma_f32_32x32x16_bf16 v[80:95], v[72:75], v[216:219], v[80:95]
s_cmp_lg_u32 s36, 2
s_cbranch_scc1 L_56
v_mfma_f32_4x4x4_16b_bf16 v[112:115], v[38:39], v[72:73], v[112:115]
v_mfma_f32_4x4x4_16b_bf16 v[116:119], v[38:39], v[74:75], v[116:119]
L_56:
ds_read_b64_tr_b16 v[72:73], v44 offset:36864
ds_read_b64_tr_b16 v[74:75], v44 offset:37376
s_waitcnt lgkmcnt(6)
v_mfma_f32_32x32x16_bf16 v[80:95], v[76:79], v[220:223], v[80:95]
s_cmp_lg_u32 s36, 3
s_cbranch_scc1 L_57
v_mfma_f32_4x4x4_16b_bf16 v[112:115], v[38:39], v[76:77], v[112:115]
v_mfma_f32_4x4x4_16b_bf16 v[116:119], v[38:39], v[78:79], v[116:119]
L_57:
s_add_u32 s67, s52, 4096
buffer_load_dwordx4 v[184:187], v29, s[20:23], s67 offen
ds_read_b64_tr_b16 v[76:77], v44 offset:38912
ds_read_b64_tr_b16 v[78:79], v44 offset:39424
s_waitcnt lgkmcnt(6)
v_mfma_f32_32x32x16_bf16 v[80:95], v[64:67], v[224:227], v[80:95]
s_cmp_lg_u32 s36, 0
s_cbranch_scc1 L_58
v_mfma_f32_4x4x4_16b_bf16 v[112:115], v[38:39], v[64:65], v[112:115]
v_mfma_f32_4x4x4_16b_bf16 v[116:119], v[38:39], v[66:67], v[116:119]
L_58:
s_add_u32 s67, s52, 118784
buffer_load_dwordx4 v[188:191], v29, s[20:23], s67 offen
s_waitcnt lgkmcnt(4)
v_mfma_f32_32x32x16_bf16 v[80:95], v[68:71], v[228:231], v[80:95]
s_cmp_lg_u32 s36, 1
s_cbranch_scc1 L_59
v_mfma_f32_4x4x4_16b_bf16 v[112:115], v[38:39], v[68:69], v[112:115]
v_mfma_f32_4x4x4_16b_bf16 v[116:119], v[38:39], v[70:71], v[116:119]
L_59:
s_waitcnt lgkmcnt(2)
v_mfma_f32_32x32x16_bf16 v[80:95], v[72:75], v[232:235], v[80:95]
s_cmp_lg_u32 s36, 2
s_cbranch_scc1 L_60
v_mfma_f32_4x4x4_16b_bf16 v[112:115], v[38:39], v[72:73], v[112:115]
v_mfma_f32_4x4x4_16b_bf16 v[116:119], v[38:39], v[74:75], v[116:119]
L_60:
s_add_u32 s67, s53, 4096
buffer_load_dwordx4 v[192:195], v29, s[20:23], s67 offen
s_waitcnt lgkmcnt(0)
v_mfma_f32_32x32x16_bf16 v[80:95], v[76:79], v[236:239], v[80:95]
s_cmp_lg_u32 s36, 3
s_cbranch_scc1 L_61
v_mfma_f32_4x4x4_16b_bf16 v[112:115], v[38:39], v[76:77], v[112:115]
v_mfma_f32_4x4x4_16b_bf16 v[116:119], v[38:39], v[78:79], v[116:119]
L_61:
s_add_u32 s67, s53, 118784
buffer_load_dwordx4 v[196:199], v29, s[20:23], s67 offen
s_lshl_b32 s38, s32, 8
s_add_u32 s38, s38, 157696
v_add_u32 v10, s38, v28
s_nop 2
v_add_f32 v12, v112, v116
ds_write_b32 v10, v12
s_waitcnt lgkmcnt(0)
s_barrier
s_branch K1TAIL
CG1_3:
s_setprio 1
v_mov_b32 v16, -1
v_mov_b32 v17, -1
v_mov_b32 v18, -1
v_mov_b32 v19, -1
v_lshrrev_b32 v10, 4, v0
s_lshl_b32 s38, s36, 3
v_add_u32 v10, s38, v10
v_and_b32 v1, 15, v0
v_lshlrev_b32 v13, 12, v10
v_lshl_add_u32 v13, v1, 4, v13
s_lshl_b32 s48, s35, 17
s_lshl_b32 s39, s34, 8
s_add_u32 s48, s48, s39
s_add_u32 s48, s48, 9437184
s_add_u32 s49, s48, 16384
s_add_u32 s51, s39, 11272192
s_waitcnt vmcnt(12) lgkmcnt(0)
s_barrier
ds_read_b128 v[128:131], v30 offset:0
ds_read_b64_tr_b16 v[64:65], v34 offset:16384
ds_read_b64_tr_b16 v[66:67], v34 offset:16896
ds_read_b128 v[132:135], v31 offset:0
ds_read_b64_tr_b16 v[68:69], v34 offset:18432
ds_read_b64_tr_b16 v[70:71], v34 offset:18944
ds_read_b128 v[136:139], v32 offset:0
ds_read_b64_tr_b16 v[72:73], v34 offset:20480
ds_read_b64_tr_b16 v[74:75], v34 offset:20992
ds_read_b128 v[140:143], v33 offset:0
ds_read_b64_tr_b16 v[76:77], v34 offset:22528
ds_read_b64_tr_b16 v[78:79], v34 offset:23040
s_waitcnt lgkmcnt(9)
v_mfma_f32_32x32x16_bf16 v[96:111], v[64:67], v[128:131], 0
v_mfma_f32_4x4x4_16b_bf16 v[48:51], v[128:129], v[128:129], 0
v_mfma_f32_4x4x4_16b_bf16 v[52:55], v[38:39], v[128:129], 0
v_mfma_f32_4x4x4_16b_bf16 v[56:59], v[130:131], v[130:131], 0
v_mfma_f32_4x4x4_16b_bf16 v[60:63], v[38:39], v[130:131], 0
s_cmp_lg_u32 s36, 0
s_cbranch_scc1 L_62
v_mfma_f32_4x4x4_16b_bf16 v[240:243], v[38:39], v[64:65], 0
v_mfma_f32_4x4x4_16b_bf16 v[244:247], v[38:39], v[66:67], 0
L_62:
s_add_u32 m0, s40, 98304
s_nop 0
buffer_load_dwordx4 v2, s[12:15], s56 offen lds
s_add_u32 m0, s40, 99328
s_nop 0
buffer_load_dwordx4 v3, s[12:15], s56 offen lds
s_waitcnt lgkmcnt(6)
v_mfma_f32_32x32x16_bf16 v[96:111], v[68:71], v[132:135], v[96:111]
v_mfma_f32_4x4x4_16b_bf16 v[48:51], v[132:133], v[132:133], v[48:51]
v_mfma_f32_4x4x4_16b_bf16 v[52:55], v[38:39], v[132:133], v[52:55]
v_mfma_f32_4x4x4_16b_bf16 v[56:59], v[134:135], v[134:135], v[56:59]
v_mfma_f32_4x4x4_16b_bf16 v[60:63], v[38:39], v[134:135], v[60:63]
s_cmp_lg_u32 s36, 1
s_cbranch_scc1 L_63
v_mfma_f32_4x4x4_16b_bf16 v[240:243], v[38:39], v[68:69], 0
v_mfma_f32_4x4x4_16b_bf16 v[244:247], v[38:39], v[70:71], 0
L_63:
s_add_u32 m0, s41, 114688
s_nop 0
buffer_load_dwordx4 v4, s[16:19], s64 offen lds
s_waitcnt vmcnt(12) lgkmcnt(0)
s_barrier
ds_read_b128 v[144:147], v30 offset:24576
ds_read_b64_tr_b16 v[64:65], v34 offset:40960
ds_read_b64_tr_b16 v[66:67], v34 offset:41472
ds_read_b128 v[148:151], v31 offset:24576
ds_read_b64_tr_b16 v[68:69], v34 offset:43008
ds_read_b64_tr_b16 v[70:71], v34 offset:43520
s_waitcnt lgkmcnt(15)
v_mfma_f32_32x32x16_bf16 v[96:111], v[72:75], v[136:139], v[96:111]
v_mfma_f32_4x4x4_16b_bf16 v[48:51], v[136:137], v[136:137], v[48:51]
v_mfma_f32_4x4x4_16b_bf16 v[52:55], v[38:39], v[136:137], v[52:55]
v_mfma_f32_4x4x4_16b_bf16 v[56:59], v[138:139], v[138:139], v[56:59]
v_mfma_f32_4x4x4_16b_bf16 v[60:63], v[38:39], v[138:139], v[60:63]
s_cmp_lg_u32 s36, 2
s_cbranch_scc1 L_64
v_mfma_f32_4x4x4_16b_bf16 v[240:243], v[38:39], v[72:73], 0
v_mfma_f32_4x4x4_16b_bf16 v[244:247], v[38:39], v[74:75], 0
L_64:
s_add_u32 m0, s40, 0
s_nop 0
buffer_load_dwordx4 v2, s[12:15], s57 offen lds
s_add_u32 m0, s40, 1024
s_nop 0
buffer_load_dwordx4 v3, s[12:15], s57 offen lds
s_waitcnt lgkmcnt(15)
v_mfma_f32_32x32x16_bf16 v[96:111], v[76:79], v[140:143], v[96:111]
v_mfma_f32_4x4x4_16b_bf16 v[48:51], v[140:141], v[140:141], v[48:51]
v_mfma_f32_4x4x4_16b_bf16 v[52:55], v[38:39], v[140:141], v[52:55]
v_mfma_f32_4x4x4_16b_bf16 v[56:59], v[142:143], v[142:143], v[56:59]
v_mfma_f32_4x4x4_16b_bf16 v[60:63], v[38:39], v[142:143], v[60:63]
s_cmp_lg_u32 s36, 3
s_cbranch_scc1 L_65
v_mfma_f32_4x4x4_16b_bf16 v[240:243], v[38:39], v[76:77], 0
v_mfma_f32_4x4x4_16b_bf16 v[244:247], v[38:39], v[78:79], 0
L_65:
s_lshl_b32 s38, s35, 3
s_add_u32 s38, s38, s32
s_mul_i32 s39, s38, 147
s_lshr_b32 s39, s39, 12
s_lshl_b32 s39, s39, 2
s_add_u32 s38, s38, s39
s_lshl_b32 s39, s34, 7
s_add_u32 s38, s38, s39
s_lshl_b32 s38, s38, 10
s_add_u32 s38, s38, 11534336
buffer_store_dwordx4 v[16:19], v29, s[20:23], s38 offen sc1
buffer_store_dwordx4 v[16:19], v13, s[20:23], s48 offen sc1
buffer_store_dwordx4 v[16:19], v13, s[20:23], s49 offen sc1
s_or_b32 s38, s35, s36
s_cmp_lg_u32 s38, 0
s_cbranch_scc1 NOSPEC2_66
s_mov_b64 exec, 0xffffffff
buffer_store_dwordx4 v[16:19], v13, s[20:23], s51 offen sc1
s_mov_b64 exec, -1
NOSPEC2_66:
s_add_u32 m0, s41, 16384
s_nop 0
buffer_load_dwordx4 v4, s[16:19], s65 offen lds
ds_read_b128 v[152:155], v32 offset:24576
ds_read_b64_tr_b16 v[72:73], v34 offset:45056
ds_read_b64_tr_b16 v[74:75], v34 offset:45568
ds_read_b128 v[156:159], v33 offset:24576
ds_read_b64_tr_b16 v[76:77], v34 offset:47104
ds_read_b64_tr_b16 v[78:79], v34 offset:47616
s_waitcnt lgkmcnt(9)
v_mfma_f32_32x32x16_bf16 v[96:111], v[64:67], v[144:147], v[96:111]
v_mfma_f32_4x4x4_16b_bf16 v[48:51], v[144:145], v[144:145], v[48:51]
v_mfma_f32_4x4x4_16b_bf16 v[52:55], v[38:39], v[144:145], v[52:55]
v_mfma_f32_4x4x4_16b_bf16 v[56:59], v[146:147], v[146:147], v[56:59]
v_mfma_f32_4x4x4_16b_bf16 v[60:63], v[38:39], v[146:147], v[60:63]
s_cmp_lg_u32 s36, 0
s_cbranch_scc1 L_67
v_mfma_f32_4x4x4_16b_bf16 v[240:243], v[38:39], v[64:65], v[240:243]
v_mfma_f32_4x4x4_16b_bf16 v[244:247], v[38:39], v[66:67], v[244:247]
L_67:
s_waitcnt lgkmcnt(6)
v_mfma_f32_32x32x16_bf16 v[96:111], v[68:71], v[148:151], v[96:111]
v_mfma_f32_4x4x4_16b_bf16 v[48:51], v[148:149], v[148:149], v[48:51]
v_mfma_f32_4x4x4_16b_bf16 v[52:55], v[38:39], v[148:149], v[52:55]
v_mfma_f32_4x4x4_16b_bf16 v[56:59], v[150:151], v[150:151], v[56:59]
v_mfma_f32_4x4x4_16b_bf16 v[60:63], v[38:39], v[150:151], v[60:63]
s_cmp_lg_u32 s36, 1
s_cbranch_scc1 L_68
v_mfma_f32_4x4x4_16b_bf16 v[240:243], v[38:39], v[68:69], v[240:243]
v_mfma_f32_4x4x4_16b_bf16 v[244:247], v[38:39], v[70:71], v[244:247]
L_68:
s_waitcnt vmcnt(15) lgkmcnt(0)
s_barrier
ds_read_b128 v[160:163], v30 offset:49152
ds_read_b64_tr_b16 v[64:65], v44 offset:0
ds_read_b64_tr_b16 v[66:67], v44 offset:512
ds_read_b128 v[164:167], v31 offset:49152
ds_read_b64_tr_b16 v[68:69], v44 offset:2048
ds_read_b64_tr_b16 v[70:71], v44 offset:2560
s_waitcnt lgkmcnt(15)
v_mfma_f32_32x32x16_bf16 v[96:111], v[72:75], v[152:155], v[96:111]
v_mfma_f32_4x4x4_16b_bf16 v[48:51], v[152:153], v[152:153], v[48:51]
v_mfma_f32_4x4x4_16b_bf16 v[52:55], v[38:39], v[152:153], v[52:55]
v_mfma_f32_4x4x4_16b_bf16 v[56:59], v[154:155], v[154:155], v[56:59]
v_mfma_f32_4x4x4_16b_bf16 v[60:63], v[38:39], v[154:155], v[60:63]
s_cmp_lg_u32 s36, 2
s_cbranch_scc1 L_69
v_mfma_f32_4x4x4_16b_bf16 v[240:243], v[38:39], v[72:73], v[240:243]
v_mfma_f32_4x4x4_16b_bf16 v[244:247], v[38:39], v[74:75], v[244:247]
L_69:
s_add_u32 m0, s40, 24576
s_nop 0
buffer_load_dwordx4 v2, s[12:15], s58 offen lds
s_add_u32 m0, s40, 25600
s_nop 0
buffer_load_dwordx4 v3, s[12:15], s58 offen lds
s_waitcnt lgkmcnt(15)
v_mfma_f32_32x32x16_bf16 v[96:111], v[76:79], v[156:159], v[96:111]
v_mfma_f32_4x4x4_16b_bf16 v[48:51], v[156:157], v[156:157], v[48:51]
v_mfma_f32_4x4x4_16b_bf16 v[52:55], v[38:39], v[156:157], v[52:55]
v_mfma_f32_4x4x4_16b_bf16 v[56:59], v[158:159], v[158:159], v[56:59]
v_mfma_f32_4x4x4_16b_bf16 v[60:63], v[38:39], v[158:159], v[60:63]
s_cmp_lg_u32 s36, 3
s_cbranch_scc1 L_70
v_mfma_f32_4x4x4_16b_bf16 v[240:243], v[38:39], v[76:77], v[240:243]
v_mfma_f32_4x4x4_16b_bf16 v[244:247], v[38:39], v[78:79], v[244:247]
L_70:
s_add_u32 m0, s41, 40960
s_nop 0
buffer_load_dwordx4 v4, s[16:19], s66 offen lds
ds_read_b128 v[168:171], v32 offset:49152
ds_read_b64_tr_b16 v[72:73], v44 offset:4096
ds_read_b64_tr_b16 v[74:75], v44 offset:4608
ds_read_b128 v[172:175], v33 offset:49152
ds_read_b64_tr_b16 v[76:77], v44 offset:6144
ds_read_b64_tr_b16 v[78:79], v44 offset:6656
s_waitcnt lgkmcnt(9)
v_mfma_f32_32x32x16_bf16 v[96:111], v[64:67], v[160:163], v[96:111]
v_mfma_f32_4x4x4_16b_bf16 v[48:51], v[160:161], v[160:161], v[48:51]
v_mfma_f32_4x4x4_16b_bf16 v[52:55], v[38:39], v[160:161], v[52:55]
v_mfma_f32_4x4x4_16b_bf16 v[56:59], v[162:163], v[162:163], v[56:59]
v_mfma_f32_4x4x4_16b_bf16 v[60:63], v[38:39], v[162:163], v[60:63]
s_cmp_lg_u32 s36, 0
s_cbranch_scc1 L_71
v_mfma_f32_4x4x4_16b_bf16 v[240:243], v[38:39], v[64:65], v[240:243]
v_mfma_f32_4x4x4_16b_bf16 v[244:247], v[38:39], v[66:67], v[244:247]
L_71:
s_waitcnt lgkmcnt(6)
v_mfma_f32_32x32x16_bf16 v[96:111], v[68:71], v[164:167], v[96:111]
v_mfma_f32_4x4x4_16b_bf16 v[48:51], v[164:165], v[164:165], v[48:51]
v_mfma_f32_4x4x4_16b_bf16 v[52:55], v[38:39], v[164:165], v[52:55]
v_mfma_f32_4x4x4_16b_bf16 v[56:59], v[166:167], v[166:167], v[56:59]
v_mfma_f32_4x4x4_16b_bf16 v[60:63], v[38:39], v[166:167], v[60:63]
s_cmp_lg_u32 s36, 1
s_cbranch_scc1 L_72
v_mfma_f32_4x4x4_16b_bf16 v[240:243], v[38:39], v[68:69], v[240:243]
v_mfma_f32_4x4x4_16b_bf16 v[244:247], v[38:39], v[70:71], v[244:247]
L_72:
s_waitcnt vmcnt(13) lgkmcnt(0)
s_barrier
ds_read_b128 v[176:179], v40 offset:8192
ds_read_b64_tr_b16 v[64:65], v44 offset:24576
ds_read_b64_tr_b16 v[66:67], v44 offset:25088
ds_read_b128 v[180:183], v41 offset:8192
ds_read_b64_tr_b16 v[68:69], v44 offset:26624
ds_read_b64_tr_b16 v[70:71], v44 offset:27136
s_waitcnt lgkmcnt(15)
v_mfma_f32_32x32x16_bf16 v[96:111], v[72:75], v[168:171], v[96:111]
v_mfma_f32_4x4x4_16b_bf16 v[48:51], v[168:169], v[168:169], v[48:51]
v_mfma_f32_4x4x4_16b_bf16 v[52:55], v[38:39], v[168:169], v[52:55]
v_mfma_f32_4x4x4_16b_bf16 v[56:59], v[170:171], v[170:171], v[56:59]
v_mfma_f32_4x4x4_16b_bf16 v[60:63], v[38:39], v[170:171], v[60:63]
s_cmp_lg_u32 s36, 2
s_cbranch_scc1 L_73
v_mfma_f32_4x4x4_16b_bf16 v[240:243], v[38:39], v[72:73], v[240:243]
v_mfma_f32_4x4x4_16b_bf16 v[244:247], v[38:39], v[74:75], v[244:247]
L_73:
s_add_u32 m0, s41, 49024
s_nop 0
buffer_load_dwordx4 v4, s[16:19], s60 offen offset:128 lds
s_add_u32 m0, s41, 57216
s_nop 0
buffer_load_dwordx4 v4, s[16:19], s61 offen offset:128 lds
s_waitcnt lgkmcnt(15)
v_mfma_f32_32x32x16_bf16 v[96:111], v[76:79], v[172:175], v[96:111]
v_mfma_f32_4x4x4_16b_bf16 v[48:51], v[172:173], v[172:173], v[48:51]
v_mfma_f32_4x4x4_16b_bf16 v[52:55], v[38:39], v[172:173], v[52:55]
v_mfma_f32_4x4x4_16b_bf16 v[56:59], v[174:175], v[174:175], v[56:59]
v_mfma_f32_4x4x4_16b_bf16 v[60:63], v[38:39], v[174:175], v[60:63]
s_cmp_lg_u32 s36, 3
s_cbranch_scc1 L_74
v_mfma_f32_4x4x4_16b_bf16 v[240:243], v[38:39], v[76:77], v[240:243]
v_mfma_f32_4x4x4_16b_bf16 v[244:247], v[38:39], v[78:79], v[244:247]
L_74:
s_add_u32 m0, s41, 65408
s_nop 0
buffer_load_dwordx4 v4, s[16:19], s62 offen offset:128 lds
ds_read_b128 v[184:187], v42 offset:8192
ds_read_b64_tr_b16 v[72:73], v44 offset:28672
ds_read_b64_tr_b16 v[74:75], v44 offset:29184
ds_read_b128 v[188:191], v43 offset:8192
ds_read_b64_tr_b16 v[76:77], v44 offset:30720
ds_read_b64_tr_b16 v[78:79], v44 offset:31232
s_waitcnt lgkmcnt(9)
v_mfma_f32_32x32x16_bf16 v[96:111], v[64:67], v[176:179], v[96:111]
v_mfma_f32_4x4x4_16b_bf16 v[48:51], v[176:177], v[176:177], v[48:51]
v_mfma_f32_4x4x4_16b_bf16 v[52:55], v[38:39], v[176:177], v[52:55]
v_mfma_f32_4x4x4_16b_bf16 v[56:59], v[178:179], v[178:179], v[56:59]
v_mfma_f32_4x4x4_16b_bf16 v[60:63], v[38:39], v[178:179], v[60:63]
s_cmp_lg_u32 s36, 0
s_cbranch_scc1 L_75
v_mfma_f32_4x4x4_16b_bf16 v[240:243], v[38:39], v[64:65], v[240:243]
v_mfma_f32_4x4x4_16b_bf16 v[244:247], v[38:39], v[66:67], v[244:247]
L_75:
s_waitcnt lgkmcnt(6)
v_mfma_f32_32x32x16_bf16 v[96:111], v[68:71], v[180:183], v[96:111]
v_mfma_f32_4x4x4_16b_bf16 v[48:51], v[180:181], v[180:181], v[48:51]
v_mfma_f32_4x4x4_16b_bf16 v[52:55], v[38:39], v[180:181], v[52:55]
v_mfma_f32_4x4x4_16b_bf16 v[56:59], v[182:183], v[182:183], v[56:59]
v_mfma_f32_4x4x4_16b_bf16 v[60:63], v[38:39], v[182:183], v[60:63]
s_cmp_lg_u32 s36, 1
s_cbranch_scc1 L_76
v_mfma_f32_4x4x4_16b_bf16 v[240:243], v[38:39], v[68:69], v[240:243]
v_mfma_f32_4x4x4_16b_bf16 v[244:247], v[38:39], v[70:71], v[244:247]
L_76:
s_waitcnt vmcnt(12) lgkmcnt(0)
s_barrier
ds_read_b128 v[192:195], v40 offset:32768
ds_read_b64_tr_b16 v[64:65], v44 offset:49152
ds_read_b64_tr_b16 v[66:67], v44 offset:49664
ds_read_b128 v[196:199], v41 offset:32768
ds_read_b64_tr_b16 v[68:69], v44 offset:51200
ds_read_b64_tr_b16 v[70:71], v44 offset:51712
s_waitcnt lgkmcnt(15)
v_mfma_f32_32x32x16_bf16 v[96:111], v[72:75], v[184:187], v[96:111]
v_mfma_f32_4x4x4_16b_bf16 v[48:51], v[184:185], v[184:185], v[48:51]
v_mfma_f32_4x4x4_16b_bf16 v[52:55], v[38:39], v[184:185], v[52:55]
v_mfma_f32_4x4x4_16b_bf16 v[56:59], v[186:187], v[186:187], v[56:59]
v_mfma_f32_4x4x4_16b_bf16 v[60:63], v[38:39], v[186:187], v[60:63]
s_cmp_lg_u32 s36, 2
s_cbranch_scc1 L_77
v_mfma_f32_4x4x4_16b_bf16 v[240:243], v[38:39], v[72:73], v[240:243]
v_mfma_f32_4x4x4_16b_bf16 v[244:247], v[38:39], v[74:75], v[244:247]
L_77:
s_add_u32 m0, s41, 73600
s_nop 0
buffer_load_dwordx4 v4, s[16:19], s63 offen offset:128 lds
s_add_u32 m0, s41, 81792
s_nop 0
buffer_load_dwordx4 v4, s[16:19], s64 offen offset:128 lds
s_waitcnt lgkmcnt(15)
v_mfma_f32_32x32x16_bf16 v[96:111], v[76:79], v[188:191], v[96:111]
v_mfma_f32_4x4x4_16b_bf16 v[48:51], v[188:189], v[188:189], v[48:51]
v_mfma_f32_4x4x4_16b_bf16 v[52:55], v[38:39], v[188:189], v[52:55]
v_mfma_f32_4x4x4_16b_bf16 v[56:59], v[190:191], v[190:191], v[56:59]
v_mfma_f32_4x4x4_16b_bf16 v[60:63], v[38:39], v[190:191], v[60:63]
s_cmp_lg_u32 s36, 3
s_cbranch_scc1 L_78
v_mfma_f32_4x4x4_16b_bf16 v[240:243], v[38:39], v[76:77], v[240:243]
v_mfma_f32_4x4x4_16b_bf16 v[244:247], v[38:39], v[78:79], v[244:247]
L_78:
s_add_u32 m0, s41, 89984
s_nop 0
buffer_load_dwordx4 v4, s[16:19], s65 offen offset:128 lds
ds_read_b128 v[200:203], v42 offset:32768
ds_read_b64_tr_b16 v[72:73], v44 offset:53248
ds_read_b64_tr_b16 v[74:75], v44 offset:53760
ds_read_b128 v[204:207], v43 offset:32768
ds_read_b64_tr_b16 v[76:77], v44 offset:55296
ds_read_b64_tr_b16 v[78:79], v44 offset:55808
s_waitcnt lgkmcnt(9)
v_mfma_f32_32x32x16_bf16 v[96:111], v[64:67], v[192:195], v[96:111]
v_mfma_f32_4x4x4_16b_bf16 v[48:51], v[192:193], v[192:193], v[48:51]
v_mfma_f32_4x4x4_16b_bf16 v[52:55], v[38:39], v[192:193], v[52:55]
v_mfma_f32_4x4x4_16b_bf16 v[56:59], v[194:195], v[194:195], v[56:59]
v_mfma_f32_4x4x4_16b_bf16 v[60:63], v[38:39], v[194:195], v[60:63]
s_cmp_lg_u32 s36, 0
s_cbranch_scc1 L_79
v_mfma_f32_4x4x4_16b_bf16 v[240:243], v[38:39], v[64:65], v[240:243]
v_mfma_f32_4x4x4_16b_bf16 v[244:247], v[38:39], v[66:67], v[244:247]
L_79:
s_waitcnt lgkmcnt(6)
v_mfma_f32_32x32x16_bf16 v[96:111], v[68:71], v[196:199], v[96:111]
v_mfma_f32_4x4x4_16b_bf16 v[48:51], v[196:197], v[196:197], v[48:51]
v_mfma_f32_4x4x4_16b_bf16 v[52:55], v[38:39], v[196:197], v[52:55]
v_mfma_f32_4x4x4_16b_bf16 v[56:59], v[198:199], v[198:199], v[56:59]
v_mfma_f32_4x4x4_16b_bf16 v[60:63], v[38:39], v[198:199], v[60:63]
s_cmp_lg_u32 s36, 1
s_cbranch_scc1 L_80
v_mfma_f32_4x4x4_16b_bf16 v[240:243], v[38:39], v[68:69], v[240:243]
v_mfma_f32_4x4x4_16b_bf16 v[244:247], v[38:39], v[70:71], v[244:247]
L_80:
s_waitcnt vmcnt(9) lgkmcnt(0)
s_barrier
ds_read_b128 v[208:211], v30 offset:0
ds_read_b64_tr_b16 v[64:65], v34 offset:16384
ds_read_b64_tr_b16 v[66:67], v34 offset:16896
ds_read_b128 v[212:215], v31 offset:0
ds_read_b64_tr_b16 v[68:69], v34 offset:18432
ds_read_b64_tr_b16 v[70:71], v34 offset:18944
s_waitcnt lgkmcnt(15)
v_mfma_f32_32x32x16_bf16 v[96:111], v[72:75], v[200:203], v[96:111]
v_mfma_f32_4x4x4_16b_bf16 v[48:51], v[200:201], v[200:201], v[48:51]
v_mfma_f32_4x4x4_16b_bf16 v[52:55], v[38:39], v[200:201], v[52:55]
v_mfma_f32_4x4x4_16b_bf16 v[56:59], v[202:203], v[202:203], v[56:59]
v_mfma_f32_4x4x4_16b_bf16 v[60:63], v[38:39], v[202:203], v[60:63]
s_cmp_lg_u32 s36, 2
s_cbranch_scc1 L_81
v_mfma_f32_4x4x4_16b_bf16 v[240:243], v[38:39], v[72:73], v[240:243]
v_mfma_f32_4x4x4_16b_bf16 v[244:247], v[38:39], v[74:75], v[244:247]
L_81:
s_add_u32 m0, s41, 98176
s_nop 0
buffer_load_dwordx4 v4, s[16:19], s66 offen offset:128 lds
s_waitcnt lgkmcnt(15)
v_mfma_f32_32x32x16_bf16 v[96:111], v[76:79], v[204:207], v[96:111]
v_mfma_f32_4x4x4_16b_bf16 v[48:51], v[204:205], v[204:205], v[48:51]
v_mfma_f32_4x4x4_16b_bf16 v[52:55], v[38:39], v[204:205], v[52:55]
v_mfma_f32_4x4x4_16b_bf16 v[56:59], v[206:207], v[206:207], v[56:59]
v_mfma_f32_4x4x4_16b_bf16 v[60:63], v[38:39], v[206:207], v[60:63]
s_cmp_lg_u32 s36, 3
s_cbranch_scc1 L_82
v_mfma_f32_4x4x4_16b_bf16 v[240:243], v[38:39], v[76:77], v[240:243]
v_mfma_f32_4x4x4_16b_bf16 v[244:247], v[38:39], v[78:79], v[244:247]
L_82:
ds_read_b128 v[216:219], v32 offset:0
ds_read_b64_tr_b16 v[72:73], v34 offset:20480
ds_read_b64_tr_b16 v[74:75], v34 offset:20992
ds_read_b128 v[220:223], v33 offset:0
ds_read_b64_tr_b16 v[76:77], v34 offset:22528
ds_read_b64_tr_b16 v[78:79], v34 offset:23040
s_waitcnt lgkmcnt(9)
v_mfma_f32_32x32x16_bf16 v[96:111], v[64:67], v[208:211], v[96:111]
v_mfma_f32_4x4x4_16b_bf16 v[48:51], v[208:209], v[208:209], v[48:51]
v_mfma_f32_4x4x4_16b_bf16 v[52:55], v[38:39], v[208:209], v[52:55]
v_mfma_f32_4x4x4_16b_bf16 v[56:59], v[210:211], v[210:211], v[56:59]
v_mfma_f32_4x4x4_16b_bf16 v[60:63], v[38:39], v[210:211], v[60:63]
s_cmp_lg_u32 s36, 0
s_cbranch_scc1 L_83
v_mfma_f32_4x4x4_16b_bf16 v[240:243], v[38:39], v[64:65], v[240:243]
v_mfma_f32_4x4x4_16b_bf16 v[244:247], v[38:39], v[66:67], v[244:247]
L_83:
s_waitcnt lgkmcnt(6)
v_mfma_f32_32x32x16_bf16 v[96:111], v[68:71], v[212:215], v[96:111]
v_mfma_f32_4x4x4_16b_bf16 v[48:51], v[212:213], v[212:213], v[48:51]
v_mfma_f32_4x4x4_16b_bf16 v[52:55], v[38:39], v[212:213], v[52:55]
v_mfma_f32_4x4x4_16b_bf16 v[56:59], v[214:215], v[214:215], v[56:59]
v_mfma_f32_4x4x4_16b_bf16 v[60:63], v[38:39], v[214:215], v[60:63]
s_cmp_lg_u32 s36, 1
s_cbranch_scc1 L_84
v_mfma_f32_4x4x4_16b_bf16 v[240:243], v[38:39], v[68:69], v[240:243]
v_mfma_f32_4x4x4_16b_bf16 v[244:247], v[38:39], v[70:71], v[244:247]
L_84:
s_waitcnt vmcnt(7) lgkmcnt(0)
s_barrier
ds_read_b128 v[224:227], v30 offset:24576
ds_read_b64_tr_b16 v[64:65], v34 offset:40960
ds_read_b64_tr_b16 v[66:67], v34 offset:41472
ds_read_b128 v[228:231], v31 offset:24576
ds_read_b64_tr_b16 v[68:69], v34 offset:43008
ds_read_b64_tr_b16 v[70:71], v34 offset:43520
s_waitcnt lgkmcnt(15)
v_mfma_f32_32x32x16_bf16 v[96:111], v[72:75], v[216:219], v[96:111]
v_mfma_f32_4x4x4_16b_bf16 v[48:51], v[216:217], v[216:217], v[48:51]
v_mfma_f32_4x4x4_16b_bf16 v[52:55], v[38:39], v[216:217], v[52:55]
v_mfma_f32_4x4x4_16b_bf16 v[56:59], v[218:219], v[218:219], v[56:59]
v_mfma_f32_4x4x4_16b_bf16 v[60:63], v[38:39], v[218:219], v[60:63]
s_cmp_lg_u32 s36, 2
s_cbranch_scc1 L_85
v_mfma_f32_4x4x4_16b_bf16 v[240:243], v[38:39], v[72:73], v[240:243]
v_mfma_f32_4x4x4_16b_bf16 v[244:247], v[38:39], v[74:75], v[244:247]
L_85:
s_waitcnt lgkmcnt(15)
v_mfma_f32_32x32x16_bf16 v[96:111], v[76:79], v[220:223], v[96:111]
v_mfma_f32_4x4x4_16b_bf16 v[48:51], v[220:221], v[220:221], v[48:51]
v_mfma_f32_4x4x4_16b_bf16 v[52:55], v[38:39], v[220:221], v[52:55]
v_mfma_f32_4x4x4_16b_bf16 v[56:59], v[222:223], v[222:223], v[56:59]
v_mfma_f32_4x4x4_16b_bf16 v[60:63], v[38:39], v[222:223], v[60:63]
s_cmp_lg_u32 s36, 3
s_cbranch_scc1 L_86
v_mfma_f32_4x4x4_16b_bf16 v[240:243], v[38:39], v[76:77], v[240:243]
v_mfma_f32_4x4x4_16b_bf16 v[244:247], v[38:39], v[78:79], v[244:247]
L_86:
ds_read_b128 v[232:235], v32 offset:24576
ds_read_b64_tr_b16 v[72:73], v34 offset:45056
ds_read_b64_tr_b16 v[74:75], v34 offset:45568
ds_read_b128 v[236:239], v33 offset:24576
ds_read_b64_tr_b16 v[76:77], v34 offset:47104
ds_read_b64_tr_b16 v[78:79], v34 offset:47616
s_waitcnt lgkmcnt(9)
v_mfma_f32_32x32x16_bf16 v[96:111], v[64:67], v[224:227], v[96:111]
v_mfma_f32_4x4x4_16b_bf16 v[48:51], v[224:225], v[224:225], v[48:51]
v_mfma_f32_4x4x4_16b_bf16 v[52:55], v[38:39], v[224:225], v[52:55]
v_mfma_f32_4x4x4_16b_bf16 v[56:59], v[226:227], v[226:227], v[56:59]
v_mfma_f32_4x4x4_16b_bf16 v[60:63], v[38:39], v[226:227], v[60:63]
s_cmp_lg_u32 s36, 0
s_cbranch_scc1 L_87
v_mfma_f32_4x4x4_16b_bf16 v[240:243], v[38:39], v[64:65], v[240:243]
v_mfma_f32_4x4x4_16b_bf16 v[244:247], v[38:39], v[66:67], v[244:247]
L_87:
s_waitcnt lgkmcnt(6)
v_mfma_f32_32x32x16_bf16 v[96:111], v[68:71], v[228:231], v[96:111]
v_mfma_f32_4x4x4_16b_bf16 v[48:51], v[228:229], v[228:229], v[48:51]
v_mfma_f32_4x4x4_16b_bf16 v[52:55], v[38:39], v[228:229], v[52:55]
v_mfma_f32_4x4x4_16b_bf16 v[56:59], v[230:231], v[230:231], v[56:59]
v_mfma_f32_4x4x4_16b_bf16 v[60:63], v[38:39], v[230:231], v[60:63]
s_cmp_lg_u32 s36, 1
s_cbranch_scc1 L_88
v_mfma_f32_4x4x4_16b_bf16 v[240:243], v[38:39], v[68:69], v[240:243]
v_mfma_f32_4x4x4_16b_bf16 v[244:247], v[38:39], v[70:71], v[244:247]
L_88:
s_cmp_lg_u32 s36, 0
s_cbranch_scc1 W2P1
buffer_load_dword v7, v28, s[24:27], 0 offen sc1
v_and_b32 v18, 3, v0
v_cmp_eq_u32 vcc, 3, v18
v_mov_b32 v18, 0x1010000
s_nop 0
v_cndmask_b32 v1, 0, v18, vcc
W2P1:
s_waitcnt lgkmcnt(3)
v_mfma_f32_32x32x16_bf16 v[96:111], v[72:75], v[232:235], v[96:111]
v_mfma_f32_4x4x4_16b_bf16 v[48:51], v[232:233], v[232:233], v[48:51]
v_mfma_f32_4x4x4_16b_bf16 v[52:55], v[38:39], v[232:233], v[52:55]
v_mfma_f32_4x4x4_16b_bf16 v[56:59], v[234:235], v[234:235], v[56:59]
v_mfma_f32_4x4x4_16b_bf16 v[60:63], v[38:39], v[234:235], v[60:63]
s_cmp_lg_u32 s36, 2
s_cbranch_scc1 L_89
v_mfma_f32_4x4x4_16b_bf16 v[240:243], v[38:39], v[72:73], v[240:243]
v_mfma_f32_4x4x4_16b_bf16 v[244:247], v[38:39], v[74:75], v[244:247]
L_89:
s_waitcnt lgkmcnt(0)
v_mfma_f32_32x32x16_bf16 v[96:111], v[76:79], v[236:239], v[96:111]
v_mfma_f32_4x4x4_16b_bf16 v[48:51], v[236:237], v[236:237], v[48:51]
v_mfma_f32_4x4x4_16b_bf16 v[52:55], v[38:39], v[236:237], v[52:55]
v_mfma_f32_4x4x4_16b_bf16 v[56:59], v[238:239], v[238:239], v[56:59]
v_mfma_f32_4x4x4_16b_bf16 v[60:63], v[38:39], v[238:239], v[60:63]
s_cmp_lg_u32 s36, 3
s_cbranch_scc1 L_90
v_mfma_f32_4x4x4_16b_bf16 v[240:243], v[38:39], v[76:77], v[240:243]
v_mfma_f32_4x4x4_16b_bf16 v[244:247], v[38:39], v[78:79], v[244:247]
L_90:
s_lshl_b32 s38, s36, 9
s_add_u32 s38, s38, 153600
v_add_u32 v10, s38, v28
v_and_b32 v12, 1, v0
v_cmp_eq_u32 vcc, 1, v12
v_and_b32 v12, 2, v0
v_cmp_eq_u32 s[48:49], 2, v12
v_add_f32 v36, v52, v60
v_add_f32 v48, v48, v56
v_add_f32 v49, v49, v57
v_add_f32 v50, v50, v58
v_add_f32 v51, v51, v59
v_cndmask_b32 v12, v48, v49, vcc
v_cndmask_b32 v13, v50, v51, vcc
v_cndmask_b32 v37, v12, v13, s[48:49]
ds_write2st64_b32 v10, v36, v37 offset0:0 offset1:1
s_lshl_b32 s38, s32, 8
s_add_u32 s38, s38, 155648
v_add_u32 v10, s38, v28
s_nop 2
v_add_f32 v12, v240, v244
ds_write_b32 v10, v12
s_waitcnt vmcnt(0) lgkmcnt(0)
s_barrier
v_lshlrev_b32 v10, 2, v5
s_lshl_b32 s38, s36, 9
s_add_u32 s38, s38, 153600
v_add_u32 v10, s38, v10
ds_read2_b32 v[12:13], v10 offset0:0 offset1:32
ds_read2_b32 v[14:15], v10 offset0:64 offset1:96
s_lshl_b32 s38, s37, 10
s_add_u32 s38, s38, 155648
v_add_u32 v11, s38, v28
ds_read2st64_b32 v[16:17], v11 offset0:0 offset1:1
ds_read2st64_b32 v[18:19], v11 offset0:2 offset1:3
v_cmp_gt_u32 vcc, 32, v0
v_mov_b32 v22, 0
v_mov_b32 v23, 0
v_mov_b32 v25, v8
v_mov_b32 v26, 0
v_mov_b32 v27, 0
s_waitcnt lgkmcnt(2)
v_add_f32 v12, v12, v13
v_add_f32 v14, v14, v15
v_mul_f32 v12, 0x3b124925, v12
v_mul_f32 v14, 0x3b124925, v14
v_fma_f32 v14, -v12, v12, v14
v_max_f32 v14, 0, v14
v_cvt_pk_bf16_f32 v14, v14, v14
v_and_b32 v14, 0xffff0000, v14
v_add_f32 v14, 0x3727c5ac, v14
v_cvt_pk_bf16_f32 v14, v14, v14
v_and_b32 v14, 0xffff0000, v14
v_sqrt_f32 v14, v14
v_cvt_pk_bf16_f32 v20, -v12, -v12
v_cvt_pk_bf16_f32 v14, v14, v14
v_and_b32 v45, 0xffff0000, v14
v_rcp_f32 v46, v45
v_lshrrev_b32 v21, 16, v45
v_cndmask_b32 v21, 0, v21, vcc
v_mul_f32 v36, 0xc0135761, v46
v_mul_f32 v37, v46, v46
v_mul_f32 v37, v37, v46
v_mul_f32 v37, 0xbdd2d3e8, v37
s_waitcnt lgkmcnt(0)
v_add_f32 v16, v16, v17
v_add_f32 v18, v18, v19
v_add_f32 v16, v16, v18
v_cvt_pk_bf16_f32 v17, v16, v16
v_and_b32 v17, 0xffff0000, v17
v_sub_f32 v18, v16, v17
v_cvt_pk_bf16_f32 v24, v17, v18
s_nop 1
v_mfma_f32_32x32x16_bf16 v[96:111], v[24:27], v[20:23], v[96:111]
s_and_b32 s38, s42, 1
s_mul_i32 s38, s38, 7
s_sub_u32 s38, s35, s38
s_mul_i32 s38, s38, 229376
s_add_u32 s38, s38, 7340032
s_mul_i32 s67, s32, 7
s_lshr_b32 s52, s67, 2
s_lshl_b32 s52, s52, 2
s_add_u32 s52, s52, s67
s_lshl_b32 s52, s52, 10
s_add_u32 s52, s52, s38
s_add_u32 s67, s67, 1
s_lshr_b32 s53, s67, 2
s_lshl_b32 s53, s53, 2
s_add_u32 s53, s53, s67
s_lshl_b32 s53, s53, 10
s_add_u32 s53, s53, s38
s_add_u32 s67, s67, 1
s_lshr_b32 s54, s67, 2
s_lshl_b32 s54, s54, 2
s_add_u32 s54, s54, s67
s_lshl_b32 s54, s54, 10
s_add_u32 s54, s54, s38
s_add_u32 s67, s67, 1
s_lshr_b32 s55, s67, 2
s_lshl_b32 s55, s55, 2
s_add_u32 s55, s55, s67
s_lshl_b32 s55, s55, 10
s_add_u32 s55, s55, s38
s_add_u32 s67, s67, 1
s_lshr_b32 s56, s67, 2
s_lshl_b32 s56, s56, 2
s_add_u32 s56, s56, s67
s_lshl_b32 s56, s56, 10
s_add_u32 s56, s56, s38
s_add_u32 s67, s67, 1
s_lshr_b32 s57, s67, 2
s_lshl_b32 s57, s57, 2
s_add_u32 s57, s57, s67
s_lshl_b32 s57, s57, 10
s_add_u32 s57, s57, s38
s_add_u32 s67, s67, 1
s_lshr_b32 s58, s67, 2
s_lshl_b32 s58, s58, 2
s_add_u32 s58, s58, s67
s_lshl_b32 s58, s58, 10
s_add_u32 s58, s58, s38
s_add_u32 s67, s67, 1
ds_read_b64_tr_b16 v[64:65], v34 offset:49152
ds_read_b64_tr_b16 v[66:67], v34 offset:49664
ds_read_b64_tr_b16 v[68:69], v34 offset:51200
ds_read_b64_tr_b16 v[70:71], v34 offset:51712
ds_read_b64_tr_b16 v[72:73], v34 offset:53248
ds_read_b64_tr_b16 v[74:75], v34 offset:53760
s_cmp_lg_u32 s36, 0
s_cbranch_scc1 PFF
s_waitcnt vmcnt(0)
PL_91:
v_and_b32 v18, v7, v1
v_cmp_ne_u32 vcc, v18, v1
s_nop 1
s_cbranch_vccz POK_92
s_sub_u32 s59, s59, 1
s_cbranch_scc1 POK_92
s_sleep 2
buffer_load_dword v7, v28, s[24:27], 0 offen sc1
s_waitcnt vmcnt(0)
s_branch PL_91
POK_92:
v_mov_b32 v1, 1
v_mov_b32 v7, 160260
s_mov_b64 exec, 1
buffer_store_dword v1, off, s[20:23], s47 sc1
ds_write_b32 v7, v1
s_mov_b64 exec, -1
s_waitcnt lgkmcnt(0)
PFF:
ds_read_b64_tr_b16 v[76:77], v34 offset:55296
ds_read_b64_tr_b16 v[78:79], v34 offset:55808
s_waitcnt lgkmcnt(6)
v_mfma_f32_32x32x16_bf16 v[80:95], v[64:67], v[128:131], 0
s_cmp_lg_u32 s36, 0
s_cbranch_scc1 L_93
v_mfma_f32_4x4x4_16b_bf16 v[112:115], v[38:39], v[64:65], 0
v_mfma_f32_4x4x4_16b_bf16 v[116:119], v[38:39], v[66:67], 0
L_93:
ds_read_b64_tr_b16 v[64:65], v34 offset:57344
ds_read_b64_tr_b16 v[66:67], v34 offset:57856
s_waitcnt lgkmcnt(6)
v_mfma_f32_32x32x16_bf16 v[80:95], v[68:71], v[132:135], v[80:95]
s_cmp_lg_u32 s36, 1
s_cbranch_scc1 L_94
v_mfma_f32_4x4x4_16b_bf16 v[112:115], v[38:39], v[68:69], 0
v_mfma_f32_4x4x4_16b_bf16 v[116:119], v[38:39], v[70:71], 0
L_94:
ds_read_b64_tr_b16 v[68:69], v34 offset:59392
ds_read_b64_tr_b16 v[70:71], v34 offset:59904
s_waitcnt lgkmcnt(6)
v_mfma_f32_32x32x16_bf16 v[80:95], v[72:75], v[136:139], v[80:95]
s_cmp_lg_u32 s36, 2
s_cbranch_scc1 L_95
v_mfma_f32_4x4x4_16b_bf16 v[112:115], v[38:39], v[72:73], 0
v_mfma_f32_4x4x4_16b_bf16 v[116:119], v[38:39], v[74:75], 0
L_95:
v_mul_f32 v240, v96, v96
v_mul_f32 v241, v97, v97
v_mul_f32 v242, v98, v98
v_mul_f32 v243, v99, v99
v_mul_f32 v244, v100, v100
v_mul_f32 v245, v101, v101
v_mul_f32 v246, v102, v102
v_mul_f32 v247, v103, v103
ds_read_b64_tr_b16 v[72:73], v34 offset:61440
ds_read_b64_tr_b16 v[74:75], v34 offset:61952
s_waitcnt lgkmcnt(6)
v_mfma_f32_32x32x16_bf16 v[80:95], v[76:79], v[140:143], v[80:95]
s_cmp_lg_u32 s36, 3
s_cbranch_scc1 L_96
v_mfma_f32_4x4x4_16b_bf16 v[112:115], v[38:39], v[76:77], 0
v_mfma_f32_4x4x4_16b_bf16 v[116:119], v[38:39], v[78:79], 0
L_96:
v_fma_f32 v240, v240, v37, v36
v_fma_f32 v241, v241, v37, v36
v_fma_f32 v242, v242, v37, v36
v_fma_f32 v243, v243, v37, v36
v_fma_f32 v244, v244, v37, v36
v_fma_f32 v245, v245, v37, v36
v_fma_f32 v246, v246, v37, v36
v_fma_f32 v247, v247, v37, v36
ds_read_b64_tr_b16 v[76:77], v34 offset:63488
ds_read_b64_tr_b16 v[78:79], v34 offset:64000
s_waitcnt lgkmcnt(6)
v_mfma_f32_32x32x16_bf16 v[80:95], v[64:67], v[144:147], v[80:95]
s_cmp_lg_u32 s36, 0
s_cbranch_scc1 L_97
v_mfma_f32_4x4x4_16b_bf16 v[112:115], v[38:39], v[64:65], v[112:115]
v_mfma_f32_4x4x4_16b_bf16 v[116:119], v[38:39], v[66:67], v[116:119]
L_97:
v_mul_f32 v240, v96, v240
v_mul_f32 v241, v97, v241
v_mul_f32 v242, v98, v242
v_mul_f32 v243, v99, v243
v_mul_f32 v244, v100, v244
v_mul_f32 v245, v101, v245
v_mul_f32 v246, v102, v246
v_mul_f32 v247, v103, v247
ds_read_b64_tr_b16 v[64:65], v44 offset:0
ds_read_b64_tr_b16 v[66:67], v44 offset:512
s_waitcnt lgkmcnt(6)
v_mfma_f32_32x32x16_bf16 v[80:95], v[68:71], v[148:151], v[80:95]
s_cmp_lg_u32 s36, 1
s_cbranch_scc1 L_98
v_mfma_f32_4x4x4_16b_bf16 v[112:115], v[38:39], v[68:69], v[112:115]
v_mfma_f32_4x4x4_16b_bf16 v[116:119], v[38:39], v[70:71], v[116:119]
L_98:
v_mov_b32 v14, 160260
WSPIN_99:
ds_read_b32 v15, v14
s_waitcnt lgkmcnt(0)
v_readfirstlane_b32 s38, v15
s_cmp_eq_u32 s38, 0
s_cbranch_scc1 WSPIN_99
v_exp_f32 v240, v240
v_exp_f32 v241, v241
v_exp_f32 v242, v242
v_exp_f32 v243, v243
ds_read_b64_tr_b16 v[68:69], v44 offset:2048
ds_read_b64_tr_b16 v[70:71], v44 offset:2560
s_waitcnt lgkmcnt(6)
v_mfma_f32_32x32x16_bf16 v[80:95], v[72:75], v[152:155], v[80:95]
s_cmp_lg_u32 s36, 2
s_cbranch_scc1 L_100
v_mfma_f32_4x4x4_16b_bf16 v[112:115], v[38:39], v[72:73], v[112:115]
v_mfma_f32_4x4x4_16b_bf16 v[116:119], v[38:39], v[74:75], v[116:119]
L_100:
buffer_load_dwordx4 v[128:131], v29, s[20:23], s52 offen
v_exp_f32 v244, v244
v_exp_f32 v245, v245
v_exp_f32 v246, v246
v_exp_f32 v247, v247
ds_read_b64_tr_b16 v[72:73], v44 offset:4096
ds_read_b64_tr_b16 v[74:75], v44 offset:4608
s_waitcnt lgkmcnt(6)
v_mfma_f32_32x32x16_bf16 v[80:95], v[76:79], v[156:159], v[80:95]
s_cmp_lg_u32 s36, 3
s_cbranch_scc1 L_101
v_mfma_f32_4x4x4_16b_bf16 v[112:115], v[38:39], v[76:77], v[112:115]
v_mfma_f32_4x4x4_16b_bf16 v[116:119], v[38:39], v[78:79], v[116:119]
L_101:
s_add_u32 s67, s52, 114688
buffer_load_dwordx4 v[132:135], v29, s[20:23], s67 offen
v_fma_f32 v240, v240, v45, v45
v_fma_f32 v241, v241, v45, v45
v_fma_f32 v242, v242, v45, v45
v_fma_f32 v243, v243, v45, v45
v_fma_f32 v244, v244, v45, v45
v_fma_f32 v245, v245, v45, v45
v_fma_f32 v246, v246, v45, v45
v_fma_f32 v247, v247, v45, v45
ds_read_b64_tr_b16 v[76:77], v44 offset:6144
ds_read_b64_tr_b16 v[78:79], v44 offset:6656
s_waitcnt lgkmcnt(6)
v_mfma_f32_32x32x16_bf16 v[80:95], v[64:67], v[160:163], v[80:95]
s_cmp_lg_u32 s36, 0
s_cbranch_scc1 L_102
v_mfma_f32_4x4x4_16b_bf16 v[112:115], v[38:39], v[64:65], v[112:115]
v_mfma_f32_4x4x4_16b_bf16 v[116:119], v[38:39], v[66:67], v[116:119]
L_102:
v_lshrrev_b32 v10, 4, v0
s_lshl_b32 s38, s36, 3
v_add_u32 v10, s38, v10
v_and_b32 v1, 15, v0
v_lshlrev_b32 v13, 12, v10
v_lshl_add_u32 v13, v1, 4, v13
s_lshl_b32 s48, s35, 17
s_lshl_b32 s39, s34, 8
s_add_u32 s48, s48, s39
s_add_u32 s48, s48, 9437184
s_add_u32 s49, s48, 16384
s_add_u32 s51, s39, 11272192
v_mov_b32 v14, 160256
v_mul_u32_u24 v12, 272, v10
v_lshl_add_u32 v12, v1, 4, v12
v_add_u32 v12, 106496, v12
v_mul_u32_u24 v15, 272, v5
v_add_u32 v15, 106752, v15
XSPIN_103:
ds_read_b32 v10, v14
s_waitcnt lgkmcnt(0)
v_readfirstlane_b32 s38, v10
s_cmp_lt_u32 s38, 4
s_cbranch_scc1 XSPIN_103
ds_read_b128 v[48:51], v12
ds_read_b128 v[52:55], v12 offset:1088
ds_read_b128 v[56:59], v15
buffer_load_dwordx4 v[136:139], v29, s[20:23], s53 offen
v_rcp_f32 v240, v240
v_rcp_f32 v241, v241
v_rcp_f32 v242, v242
v_rcp_f32 v243, v243
ds_read_b64_tr_b16 v[64:65], v44 offset:8192
ds_read_b64_tr_b16 v[66:67], v44 offset:8704
s_waitcnt lgkmcnt(6)
v_mfma_f32_32x32x16_bf16 v[80:95], v[68:71], v[164:167], v[80:95]
s_cmp_lg_u32 s36, 1
s_cbranch_scc1 L_104
v_mfma_f32_4x4x4_16b_bf16 v[112:115], v[38:39], v[68:69], v[112:115]
v_mfma_f32_4x4x4_16b_bf16 v[116:119], v[38:39], v[70:71], v[116:119]
L_104:
s_waitcnt lgkmcnt(2)
buffer_store_dwordx4 v[48:51], v13, s[20:23], s48 offen sc1
buffer_store_dwordx4 v[52:55], v13, s[20:23], s49 offen sc1
s_or_b32 s38, s35, s36
s_cmp_lg_u32 s38, 0
s_cbranch_scc1 NOSPEC2_105
s_mov_b64 exec, 0xffffffff
buffer_store_dwordx4 v[56:59], v13, s[20:23], s51 offen sc1
s_mov_b64 exec, -1
NOSPEC2_105:
v_rcp_f32 v244, v244
v_rcp_f32 v245, v245
v_rcp_f32 v246, v246
v_rcp_f32 v247, v247
ds_read_b64_tr_b16 v[68:69], v44 offset:10240
ds_read_b64_tr_b16 v[70:71], v44 offset:10752
s_waitcnt lgkmcnt(6)
v_mfma_f32_32x32x16_bf16 v[80:95], v[72:75], v[168:171], v[80:95]
s_cmp_lg_u32 s36, 2
s_cbranch_scc1 L_106
v_mfma_f32_4x4x4_16b_bf16 v[112:115], v[38:39], v[72:73], v[112:115]
v_mfma_f32_4x4x4_16b_bf16 v[116:119], v[38:39], v[74:75], v[116:119]
L_106:
s_add_u32 s67, s53, 114688
buffer_load_dwordx4 v[140:143], v29, s[20:23], s67 offen
v_mul_f32 v240, v96, v240
v_mul_f32 v241, v97, v241
v_mul_f32 v242, v98, v242
v_mul_f32 v243, v99, v243
v_mul_f32 v244, v100, v244
v_mul_f32 v245, v101, v245
v_mul_f32 v246, v102, v246
v_mul_f32 v247, v103, v247
ds_read_b64_tr_b16 v[72:73], v44 offset:12288
ds_read_b64_tr_b16 v[74:75], v44 offset:12800
s_waitcnt lgkmcnt(6)
v_mfma_f32_32x32x16_bf16 v[80:95], v[76:79], v[172:175], v[80:95]
s_cmp_lg_u32 s36, 3
s_cbranch_scc1 L_107
v_mfma_f32_4x4x4_16b_bf16 v[112:115], v[38:39], v[76:77], v[112:115]
v_mfma_f32_4x4x4_16b_bf16 v[116:119], v[38:39], v[78:79], v[116:119]
L_107:
buffer_load_dwordx4 v[144:147], v29, s[20:23], s54 offen
v_cvt_pk_bf16_f32 v248, v240, v241
v_cvt_pk_bf16_f32 v249, v242, v243
v_cvt_pk_bf16_f32 v250, v244, v245
v_cvt_pk_bf16_f32 v251, v246, v247
buffer_store_dwordx4 v[248:251], v29, s[20:23], s45 offen offset:0 sc1
v_mul_f32 v240, v104, v104
v_mul_f32 v241, v105, v105
v_mul_f32 v242, v106, v106
ds_read_b64_tr_b16 v[76:77], v44 offset:14336
ds_read_b64_tr_b16 v[78:79], v44 offset:14848
s_waitcnt lgkmcnt(6)
v_mfma_f32_32x32x16_bf16 v[80:95], v[64:67], v[176:179], v[80:95]
s_cmp_lg_u32 s36, 0
s_cbranch_scc1 L_108
v_mfma_f32_4x4x4_16b_bf16 v[112:115], v[38:39], v[64:65], v[112:115]
v_mfma_f32_4x4x4_16b_bf16 v[116:119], v[38:39], v[66:67], v[116:119]
L_108:
s_add_u32 s67, s54, 114688
buffer_load_dwordx4 v[148:151], v29, s[20:23], s67 offen
v_mul_f32 v243, v107, v107
v_mul_f32 v244, v108, v108
v_mul_f32 v245, v109, v109
v_mul_f32 v246, v110, v110
v_mul_f32 v247, v111, v111
v_fma_f32 v240, v240, v37, v36
v_fma_f32 v241, v241, v37, v36
v_fma_f32 v242, v242, v37, v36
ds_read_b64_tr_b16 v[64:65], v44 offset:16384
ds_read_b64_tr_b16 v[66:67], v44 offset:16896
s_waitcnt lgkmcnt(6)
v_mfma_f32_32x32x16_bf16 v[80:95], v[68:71], v[180:183], v[80:95]
s_cmp_lg_u32 s36, 1
s_cbranch_scc1 L_109
v_mfma_f32_4x4x4_16b_bf16 v[112:115], v[38:39], v[68:69], v[112:115]
v_mfma_f32_4x4x4_16b_bf16 v[116:119], v[38:39], v[70:71], v[116:119]
L_109:
buffer_load_dwordx4 v[152:155], v29, s[20:23], s55 offen
v_fma_f32 v243, v243, v37, v36
v_fma_f32 v244, v244, v37, v36
v_fma_f32 v245, v245, v37, v36
v_fma_f32 v246, v246, v37, v36
v_fma_f32 v247, v247, v37, v36
v_mul_f32 v240, v104, v240
v_mul_f32 v241, v105, v241
v_mul_f32 v242, v106, v242
ds_read_b64_tr_b16 v[68:69], v44 offset:18432
ds_read_b64_tr_b16 v[70:71], v44 offset:18944
s_waitcnt lgkmcnt(6)
v_mfma_f32_32x32x16_bf16 v[80:95], v[72:75], v[184:187], v[80:95]
s_cmp_lg_u32 s36, 2
s_cbranch_scc1 L_110
v_mfma_f32_4x4x4_16b_bf16 v[112:115], v[38:39], v[72:73], v[112:115]
v_mfma_f32_4x4x4_16b_bf16 v[116:119], v[38:39], v[74:75], v[116:119]
L_110:
v_mul_f32 v243, v107, v243
v_mul_f32 v244, v108, v244
v_mul_f32 v245, v109, v245
v_mul_f32 v246, v110, v246
v_mul_f32 v247, v111, v247
v_exp_f32 v240, v240
v_exp_f32 v241, v241
ds_read_b64_tr_b16 v[72:73], v44 offset:20480
ds_read_b64_tr_b16 v[74:75], v44 offset:20992
s_waitcnt lgkmcnt(6)
v_mfma_f32_32x32x16_bf16 v[80:95], v[76:79], v[188:191], v[80:95]
s_cmp_lg_u32 s36, 3
s_cbranch_scc1 L_111
v_mfma_f32_4x4x4_16b_bf16 v[112:115], v[38:39], v[76:77], v[112:115]
v_mfma_f32_4x4x4_16b_bf16 v[116:119], v[38:39], v[78:79], v[116:119]
L_111:
s_add_u32 s67, s55, 114688
buffer_load_dwordx4 v[156:159], v29, s[20:23], s67 offen
v_exp_f32 v242, v242
v_exp_f32 v243, v243
v_exp_f32 v244, v244
v_exp_f32 v245, v245
ds_read_b64_tr_b16 v[76:77], v44 offset:22528
ds_read_b64_tr_b16 v[78:79], v44 offset:23040
s_waitcnt lgkmcnt(6)
v_mfma_f32_32x32x16_bf16 v[80:95], v[64:67], v[192:195], v[80:95]
s_cmp_lg_u32 s36, 0
s_cbranch_scc1 L_112
v_mfma_f32_4x4x4_16b_bf16 v[112:115], v[38:39], v[64:65], v[112:115]
v_mfma_f32_4x4x4_16b_bf16 v[116:119], v[38:39], v[66:67], v[116:119]
L_112:
buffer_load_dwordx4 v[160:163], v29, s[20:23], s56 offen
v_exp_f32 v246, v246
v_exp_f32 v247, v247
v_fma_f32 v240, v240, v45, v45
v_fma_f32 v241, v241, v45, v45
v_fma_f32 v242, v242, v45, v45
v_fma_f32 v243, v243, v45, v45
ds_read_b64_tr_b16 v[64:65], v44 offset:24576
ds_read_b64_tr_b16 v[66:67], v44 offset:25088
s_waitcnt lgkmcnt(6)
v_mfma_f32_32x32x16_bf16 v[80:95], v[68:71], v[196:199], v[80:95]
s_cmp_lg_u32 s36, 1
s_cbranch_scc1 L_113
v_mfma_f32_4x4x4_16b_bf16 v[112:115], v[38:39], v[68:69], v[112:115]
v_mfma_f32_4x4x4_16b_bf16 v[116:119], v[38:39], v[70:71], v[116:119]
L_113:
s_add_u32 s67, s56, 114688
buffer_load_dwordx4 v[164:167], v29, s[20:23], s67 offen
v_fma_f32 v244, v244, v45, v45
v_fma_f32 v245, v245, v45, v45
v_fma_f32 v246, v246, v45, v45
v_fma_f32 v247, v247, v45, v45
v_rcp_f32 v240, v240
v_rcp_f32 v241, v241
ds_read_b64_tr_b16 v[68:69], v44 offset:26624
ds_read_b64_tr_b16 v[70:71], v44 offset:27136
s_waitcnt lgkmcnt(6)
v_mfma_f32_32x32x16_bf16 v[80:95], v[72:75], v[200:203], v[80:95]
s_cmp_lg_u32 s36, 2
s_cbranch_scc1 L_114
v_mfma_f32_4x4x4_16b_bf16 v[112:115], v[38:39], v[72:73], v[112:115]
v_mfma_f32_4x4x4_16b_bf16 v[116:119], v[38:39], v[74:75], v[116:119]
L_114:
s_cmp_lg_u32 s36, 0
s_cbranch_scc1 HP1
v_min_u32 v1, 13, v0
s_lshl_b32 s38, s34, 12
s_add_u32 s38, s38, 13631488
v_lshl_add_u32 v1, v1, 8, s38
buffer_load_dword v7, v1, s[20:23], 0 offen sc1
HP1:
v_rcp_f32 v242, v242
v_rcp_f32 v243, v243
v_rcp_f32 v244, v244
v_rcp_f32 v245, v245
ds_read_b64_tr_b16 v[72:73], v44 offset:28672
ds_read_b64_tr_b16 v[74:75], v44 offset:29184
s_waitcnt lgkmcnt(6)
v_mfma_f32_32x32x16_bf16 v[80:95], v[76:79], v[204:207], v[80:95]
s_cmp_lg_u32 s36, 3
s_cbranch_scc1 L_115
v_mfma_f32_4x4x4_16b_bf16 v[112:115], v[38:39], v[76:77], v[112:115]
v_mfma_f32_4x4x4_16b_bf16 v[116:119], v[38:39], v[78:79], v[116:119]
L_115:
buffer_load_dwordx4 v[168:171], v29, s[20:23], s57 offen
v_rcp_f32 v246, v246
v_rcp_f32 v247, v247
v_mul_f32 v240, v104, v240
v_mul_f32 v241, v105, v241
v_mul_f32 v242, v106, v242
v_mul_f32 v243, v107, v243
ds_read_b64_tr_b16 v[76:77], v44 offset:30720
ds_read_b64_tr_b16 v[78:79], v44 offset:31232
s_waitcnt lgkmcnt(6)
v_mfma_f32_32x32x16_bf16 v[80:95], v[64:67], v[208:211], v[80:95]
s_cmp_lg_u32 s36, 0
s_cbranch_scc1 L_116
v_mfma_f32_4x4x4_16b_bf16 v[112:115], v[38:39], v[64:65], v[112:115]
v_mfma_f32_4x4x4_16b_bf16 v[116:119], v[38:39], v[66:67], v[116:119]
L_116:
s_add_u32 s67, s57, 114688
buffer_load_dwordx4 v[172:175], v29, s[20:23], s67 offen
v_mul_f32 v244, v108, v244
v_mul_f32 v245, v109, v245
v_mul_f32 v246, v110, v246
v_mul_f32 v247, v111, v247
v_cvt_pk_bf16_f32 v252, v240, v241
v_cvt_pk_bf16_f32 v253, v242, v243
v_cvt_pk_bf16_f32 v254, v244, v245
v_cvt_pk_bf16_f32 v255, v246, v247
ds_read_b64_tr_b16 v[64:65], v44 offset:32768
ds_read_b64_tr_b16 v[66:67], v44 offset:33280
s_waitcnt lgkmcnt(6)
v_mfma_f32_32x32x16_bf16 v[80:95], v[68:71], v[212:215], v[80:95]
s_cmp_lg_u32 s36, 1
s_cbranch_scc1 L_117
v_mfma_f32_4x4x4_16b_bf16 v[112:115], v[38:39], v[68:69], v[112:115]
v_mfma_f32_4x4x4_16b_bf16 v[116:119], v[38:39], v[70:71], v[116:119]
L_117:
buffer_load_dwordx4 v[176:179], v29, s[20:23], s58 offen
buffer_store_dwordx4 v[252:255], v29, s[20:23], s45 offen offset:1024 sc1
ds_read_b64_tr_b16 v[68:69], v44 offset:34816
ds_read_b64_tr_b16 v[70:71], v44 offset:35328
s_waitcnt lgkmcnt(6)
v_mfma_f32_32x32x16_bf16 v[80:95], v[72:75], v[216:219], v[80:95]
s_cmp_lg_u32 s36, 2
s_cbranch_scc1 L_118
v_mfma_f32_4x4x4_16b_bf16 v[112:115], v[38:39], v[72:73], v[112:115]
v_mfma_f32_4x4x4_16b_bf16 v[116:119], v[38:39], v[74:75], v[116:119]
L_118:
s_add_u32 s67, s58, 114688
buffer_load_dwordx4 v[180:183], v29, s[20:23], s67 offen
ds_read_b64_tr_b16 v[72:73], v44 offset:36864
ds_read_b64_tr_b16 v[74:75], v44 offset:37376
s_waitcnt lgkmcnt(6)
v_mfma_f32_32x32x16_bf16 v[80:95], v[76:79], v[220:223], v[80:95]
s_cmp_lg_u32 s36, 3
s_cbranch_scc1 L_119
v_mfma_f32_4x4x4_16b_bf16 v[112:115], v[38:39], v[76:77], v[112:115]
v_mfma_f32_4x4x4_16b_bf16 v[116:119], v[38:39], v[78:79], v[116:119]
L_119:
ds_read_b64_tr_b16 v[76:77], v44 offset:38912
ds_read_b64_tr_b16 v[78:79], v44 offset:39424
s_waitcnt lgkmcnt(6)
v_mfma_f32_32x32x16_bf16 v[80:95], v[64:67], v[224:227], v[80:95]
s_cmp_lg_u32 s36, 0
s_cbranch_scc1 L_120
v_mfma_f32_4x4x4_16b_bf16 v[112:115], v[38:39], v[64:65], v[112:115]
v_mfma_f32_4x4x4_16b_bf16 v[116:119], v[38:39], v[66:67], v[116:119]
L_120:
s_add_u32 s67, s52, 4096
buffer_load_dwordx4 v[184:187], v29, s[20:23], s67 offen
s_waitcnt lgkmcnt(4)
v_mfma_f32_32x32x16_bf16 v[80:95], v[68:71], v[228:231], v[80:95]
s_cmp_lg_u32 s36, 1
s_cbranch_scc1 L_121
v_mfma_f32_4x4x4_16b_bf16 v[112:115], v[38:39], v[68:69], v[112:115]
v_mfma_f32_4x4x4_16b_bf16 v[116:119], v[38:39], v[70:71], v[116:119]
L_121:
s_add_u32 s67, s52, 118784
buffer_load_dwordx4 v[188:191], v29, s[20:23], s67 offen
s_waitcnt lgkmcnt(2)
v_mfma_f32_32x32x16_bf16 v[80:95], v[72:75], v[232:235], v[80:95]
s_cmp_lg_u32 s36, 2
s_cbranch_scc1 L_122
v_mfma_f32_4x4x4_16b_bf16 v[112:115], v[38:39], v[72:73], v[112:115]
v_mfma_f32_4x4x4_16b_bf16 v[116:119], v[38:39], v[74:75], v[116:119]
L_122:
s_add_u32 s67, s53, 4096
buffer_load_dwordx4 v[192:195], v29, s[20:23], s67 offen
s_waitcnt lgkmcnt(0)
v_mfma_f32_32x32x16_bf16 v[80:95], v[76:79], v[236:239], v[80:95]
s_cmp_lg_u32 s36, 3
s_cbranch_scc1 L_123
v_mfma_f32_4x4x4_16b_bf16 v[112:115], v[38:39], v[76:77], v[112:115]
v_mfma_f32_4x4x4_16b_bf16 v[116:119], v[38:39], v[78:79], v[116:119]
L_123:
s_add_u32 s67, s53, 118784
buffer_load_dwordx4 v[196:199], v29, s[20:23], s67 offen
s_and_b32 s38, s42, 1
s_lshl_b32 s39, s34, 1
s_add_u32 s38, s38, s39
s_lshl_b32 s38, s38, 1
s_add_u32 s38, s38, 0
v_lshl_add_u32 v48, v5, 6, s38
s_lshl_b32 s39, s36, 3
v_lshl_add_u32 v49, v6, 2, s39
v_cvt_f32_u32 v48, v48
v_cvt_f32_u32 v49, v49
v_mul_f32 v48, 0x3a000000, v48
v_mul_f32 v49, v49, v48
v_fmamk_f32 v12, v48, 0x00000000, v49
v_fmamk_f32 v13, v48, 0x3f800000, v49
v_fmamk_f32 v14, v48, 0x40000000, v49
v_fmamk_f32 v15, v48, 0x40400000, v49
v_sin_f32 v16, v12
v_sin_f32 v17, v13
v_sin_f32 v18, v14
v_sin_f32 v19, v15
v_cos_f32 v12, v12
v_cos_f32 v13, v13
v_cos_f32 v14, v14
v_cos_f32 v15, v15
s_lshl_b32 s38, s36, 11
s_add_u32 s38, s38, 131072
v_add_u32 v10, s38, v29
v_cvt_pk_bf16_f32 v48, v12, -v16
v_cvt_pk_bf16_f32 v49, v13, -v17
v_cvt_pk_bf16_f32 v50, v14, -v18
v_cvt_pk_bf16_f32 v51, v15, -v19
v_cvt_pk_bf16_f32 v12, v16, v12
v_cvt_pk_bf16_f32 v13, v17, v13
v_cvt_pk_bf16_f32 v14, v18, v14
v_cvt_pk_bf16_f32 v15, v19, v15
ds_write_b128 v10, v[48:51]
ds_write_b128 v10, v[12:15] offset:1024
s_and_b32 s38, s42, 1
s_lshl_b32 s39, s34, 1
s_add_u32 s38, s38, s39
s_lshl_b32 s38, s38, 1
s_add_u32 s38, s38, 1
v_lshl_add_u32 v52, v5, 6, s38
s_lshl_b32 s39, s36, 3
v_lshl_add_u32 v53, v6, 2, s39
v_cvt_f32_u32 v52, v52
v_cvt_f32_u32 v53, v53
v_mul_f32 v52, 0x3a000000, v52
v_mul_f32 v53, v53, v52
v_fmamk_f32 v12, v52, 0x00000000, v53
v_fmamk_f32 v13, v52, 0x3f800000, v53
v_fmamk_f32 v14, v52, 0x40000000, v53
v_fmamk_f32 v15, v52, 0x40400000, v53
v_sin_f32 v16, v12
v_sin_f32 v17, v13
v_sin_f32 v18, v14
v_sin_f32 v19, v15
v_cos_f32 v12, v12
v_cos_f32 v13, v13
v_cos_f32 v14, v14
v_cos_f32 v15, v15
s_lshl_b32 s38, s36, 11
s_add_u32 s38, s38, 139264
v_add_u32 v10, s38, v29
v_cvt_pk_bf16_f32 v52, v12, -v16
v_cvt_pk_bf16_f32 v53, v13, -v17
v_cvt_pk_bf16_f32 v54, v14, -v18
v_cvt_pk_bf16_f32 v55, v15, -v19
v_cvt_pk_bf16_f32 v12, v16, v12
v_cvt_pk_bf16_f32 v13, v17, v13
v_cvt_pk_bf16_f32 v14, v18, v14
v_cvt_pk_bf16_f32 v15, v19, v15
ds_write_b128 v10, v[52:55]
ds_write_b128 v10, v[12:15] offset:1024
s_cmp_lg_u32 s36, 0
s_cbranch_scc1 HP2
s_waitcnt vmcnt(9)
PL_124:
v_cmp_ne_u32 vcc, 1, v7
s_nop 1
s_cbranch_vccz POK_125
s_sub_u32 s59, s59, 1
s_cbranch_scc1 POK_125
s_sleep 2
buffer_load_dword v7, v1, s[20:23], 0 offen sc1
s_waitcnt vmcnt(0)
s_branch PL_124
POK_125:
HP2:
s_lshl_b32 s38, s32, 8
s_add_u32 s38, s38, 157696
v_add_u32 v10, s38, v28
s_nop 2
v_add_f32 v12, v112, v116
ds_write_b32 v10, v12
s_waitcnt lgkmcnt(0)
s_barrier
K1TAIL:
v_add_u32 v11, 2048, v11
ds_read2st64_b32 v[16:17], v11 offset0:0 offset1:1
ds_read2st64_b32 v[18:19], v11 offset0:2 offset1:3
v_mov_b32 v25, v9
s_waitcnt lgkmcnt(0)
v_add_f32 v16, v16, v17
v_add_f32 v18, v18, v19
v_add_f32 v16, v16, v18
v_cvt_pk_bf16_f32 v17, v16, v16
v_and_b32 v17, 0xffff0000, v17
v_sub_f32 v18, v16, v17
v_cvt_pk_bf16_f32 v24, v17, v18
s_nop 1
v_mfma_f32_32x32x16_bf16 v[80:95], v[24:27], v[20:23], v[80:95]
s_add_u32 s67, s54, 4096
buffer_load_dwordx4 v[200:203], v29, s[20:23], s67 offen
s_add_u32 s67, s54, 118784
buffer_load_dwordx4 v[204:207], v29, s[20:23], s67 offen
s_add_u32 s67, s55, 4096
buffer_load_dwordx4 v[208:211], v29, s[20:23], s67 offen
s_add_u32 s67, s55, 118784
buffer_load_dwordx4 v[212:215], v29, s[20:23], s67 offen
s_nop 7
s_nop 3
v_mul_f32 v240, v80, v80
v_mul_f32 v241, v81, v81
v_mul_f32 v242, v82, v82
v_mul_f32 v243, v83, v83
v_mul_f32 v244, v84, v84
v_mul_f32 v245, v85, v85
v_mul_f32 v246, v86, v86
v_mul_f32 v247, v87, v87
v_fma_f32 v240, v240, v37, v36
v_fma_f32 v241, v241, v37, v36
v_fma_f32 v242, v242, v37, v36
v_fma_f32 v243, v243, v37, v36
v_fma_f32 v244, v244, v37, v36
v_fma_f32 v245, v245, v37, v36
v_fma_f32 v246, v246, v37, v36
v_fma_f32 v247, v247, v37, v36
v_mul_f32 v240, v80, v240
v_mul_f32 v241, v81, v241
v_mul_f32 v242, v82, v242
v_mul_f32 v243, v83, v243
v_mul_f32 v244, v84, v244
v_mul_f32 v245, v85, v245
v_mul_f32 v246, v86, v246
v_mul_f32 v247, v87, v247
v_exp_f32 v240, v240
v_exp_f32 v241, v241
v_exp_f32 v242, v242
v_exp_f32 v243, v243
v_exp_f32 v244, v244
v_exp_f32 v245, v245
v_mov_b32 v10, 160264
v_mov_b32 v11, 1
s_mov_b64 exec, 1
s_waitcnt vmcnt(8)
ds_add_rtn_u32 v11, v10, v11
v_mov_b32 v10, 1
s_add_u32 s68, s47, 65536
s_waitcnt lgkmcnt(0)
v_readfirstlane_b32 s67, v11
s_cmp_lg_u32 s67, 7
s_cbranch_scc1 SG_126
buffer_store_dword v10, off, s[20:23], s68 sc1
SG_126:
s_mov_b64 exec, -1
v_exp_f32 v246, v246
v_exp_f32 v247, v247
v_fma_f32 v240, v240, v45, v45
v_fma_f32 v241, v241, v45, v45
v_fma_f32 v242, v242, v45, v45
v_fma_f32 v243, v243, v45, v45
v_fma_f32 v244, v244, v45, v45
v_fma_f32 v245, v245, v45, v45
v_fma_f32 v246, v246, v45, v45
v_fma_f32 v247, v247, v45, v45
v_rcp_f32 v240, v240
v_rcp_f32 v241, v241
v_rcp_f32 v242, v242
v_rcp_f32 v243, v243
v_rcp_f32 v244, v244
v_rcp_f32 v245, v245
v_rcp_f32 v246, v246
v_rcp_f32 v247, v247
v_mul_f32 v240, v80, v240
v_mul_f32 v241, v81, v241
v_mul_f32 v242, v82, v242
v_mul_f32 v243, v83, v243
v_mul_f32 v244, v84, v244
v_mul_f32 v245, v85, v245
v_mul_f32 v246, v86, v246
v_mul_f32 v247, v87, v247
v_cvt_pk_bf16_f32 v248, v240, v241
v_cvt_pk_bf16_f32 v249, v242, v243
v_cvt_pk_bf16_f32 v250, v244, v245
v_cvt_pk_bf16_f32 v251, v246, v247
buffer_store_dwordx4 v[248:251], v29, s[20:23], s46 offen offset:0 sc1
v_mul_f32 v240, v88, v88
v_mul_f32 v241, v89, v89
v_mul_f32 v242, v90, v90
v_mul_f32 v243, v91, v91
v_mul_f32 v244, v92, v92
v_mul_f32 v245, v93, v93
v_mul_f32 v246, v94, v94
v_mul_f32 v247, v95, v95
v_fma_f32 v240, v240, v37, v36
v_fma_f32 v241, v241, v37, v36
v_fma_f32 v242, v242, v37, v36
v_fma_f32 v243, v243, v37, v36
v_fma_f32 v244, v244, v37, v36
v_fma_f32 v245, v245, v37, v36
v_fma_f32 v246, v246, v37, v36
v_fma_f32 v247, v247, v37, v36
v_mul_f32 v240, v88, v240
v_mul_f32 v241, v89, v241
v_mul_f32 v242, v90, v242
v_mul_f32 v243, v91, v243
v_mul_f32 v244, v92, v244
v_mul_f32 v245, v93, v245
v_mul_f32 v246, v94, v246
v_mul_f32 v247, v95, v247
v_exp_f32 v240, v240
v_exp_f32 v241, v241
v_exp_f32 v242, v242
v_exp_f32 v243, v243
v_exp_f32 v244, v244
v_exp_f32 v245, v245
v_exp_f32 v246, v246
v_exp_f32 v247, v247
v_fma_f32 v240, v240, v45, v45
v_fma_f32 v241, v241, v45, v45
v_fma_f32 v242, v242, v45, v45
v_fma_f32 v243, v243, v45, v45
v_fma_f32 v244, v244, v45, v45
v_fma_f32 v245, v245, v45, v45
v_fma_f32 v246, v246, v45, v45
v_fma_f32 v247, v247, v45, v45
v_rcp_f32 v240, v240
v_rcp_f32 v241, v241
v_rcp_f32 v242, v242
v_rcp_f32 v243, v243
v_rcp_f32 v244, v244
v_rcp_f32 v245, v245
v_rcp_f32 v246, v246
v_rcp_f32 v247, v247
v_mul_f32 v240, v88, v240
v_mul_f32 v241, v89, v241
v_mul_f32 v242, v90, v242
v_mul_f32 v243, v91, v243
v_mul_f32 v244, v92, v244
v_mul_f32 v245, v93, v245
v_mul_f32 v246, v94, v246
v_mul_f32 v247, v95, v247
v_cvt_pk_bf16_f32 v252, v240, v241
v_cvt_pk_bf16_f32 v253, v242, v243
v_cvt_pk_bf16_f32 v254, v244, v245
v_cvt_pk_bf16_f32 v255, v246, v247
buffer_store_dwordx4 v[252:255], v29, s[20:23], s46 offen offset:1024 sc1
s_setprio 0
s_load_dwordx4 s[8:11], s[0:1], 56
s_and_b32 s38, s42, 1
s_mul_i32 s39, s38, 7
s_sub_u32 s35, s35, s39
s_lshl_b32 s33, s34, 1
s_add_u32 s33, s33, s38
s_lshl_b32 s33, s33, 1
s_mul_i32 s39, s33, 114688
s_mul_i32 s67, s32, 7
s_lshr_b32 s60, s67, 2
s_lshl_b32 s60, s60, 2
s_add_u32 s60, s60, s67
s_lshl_b32 s60, s60, 10
s_add_u32 s60, s60, s39
s_add_u32 s67, s67, 1
s_lshr_b32 s61, s67, 2
s_lshl_b32 s61, s61, 2
s_add_u32 s61, s61, s67
s_lshl_b32 s61, s61, 10
s_add_u32 s61, s61, s39
s_add_u32 s67, s67, 1
s_lshr_b32 s62, s67, 2
s_lshl_b32 s62, s62, 2
s_add_u32 s62, s62, s67
s_lshl_b32 s62, s62, 10
s_add_u32 s62, s62, s39
s_add_u32 s67, s67, 1
s_lshr_b32 s63, s67, 2
s_lshl_b32 s63, s63, 2
s_add_u32 s63, s63, s67
s_lshl_b32 s63, s63, 10
s_add_u32 s63, s63, s39
s_add_u32 s67, s67, 1
s_lshr_b32 s64, s67, 2
s_lshl_b32 s64, s64, 2
s_add_u32 s64, s64, s67
s_lshl_b32 s64, s64, 10
s_add_u32 s64, s64, s39
s_add_u32 s67, s67, 1
s_lshr_b32 s65, s67, 2
s_lshl_b32 s65, s65, 2
s_add_u32 s65, s65, s67
s_lshl_b32 s65, s65, 10
s_add_u32 s65, s65, s39
s_add_u32 s67, s67, 1
s_lshr_b32 s66, s67, 2
s_lshl_b32 s66, s66, 2
s_add_u32 s66, s66, s67
s_lshl_b32 s66, s66, 10
s_add_u32 s66, s66, s39
s_add_u32 s67, s67, 1
v_add_u32 v1, 131072, v29
v_mov_b32 v15, v29
s_mul_i32 s38, s32, 7
s_add_u32 s67, s38, 6
s_lshr_b32 s38, s38, 2
s_lshr_b32 s67, s67, 2
v_add_u32 v14, s38, v0
v_min_u32 v14, s67, v14
s_lshl_b32 s38, s34, 12
s_add_u32 s38, s38, 13697024
v_lshl_add_u32 v14, v14, 8, s38
buffer_load_dword v3, v14, s[20:23], 0 offen sc1
s_add_u32 s67, s56, 4096
buffer_load_dwordx4 v[216:219], v15, s[20:23], s67 offen
s_add_u32 s67, s56, 118784
buffer_load_dwordx4 v[220:223], v15, s[20:23], s67 offen
s_add_u32 s67, s57, 4096
buffer_load_dwordx4 v[224:227], v15, s[20:23], s67 offen
s_add_u32 s67, s57, 118784
buffer_load_dwordx4 v[228:231], v15, s[20:23], s67 offen
s_add_u32 s67, s58, 4096
buffer_load_dwordx4 v[232:235], v15, s[20:23], s67 offen
s_add_u32 s67, s58, 118784
buffer_load_dwordx4 v[236:239], v15, s[20:23], s67 offen
v_mov_b32 v10, 160268
v_mov_b32 v11, 1
s_mov_b64 exec, 1
s_waitcnt vmcnt(7)
ds_add_rtn_u32 v11, v10, v11
v_mov_b32 v10, 1
s_add_u32 s68, s47, 131072
s_waitcnt lgkmcnt(0)
v_readfirstlane_b32 s67, v11
s_cmp_lg_u32 s67, 7
s_cbranch_scc1 SG_127
buffer_store_dword v10, off, s[20:23], s68 sc1
SG_127:
s_mov_b64 exec, -1
s_waitcnt vmcnt(6)
PL_128:
v_cmp_ne_u32 vcc, 1, v3
s_nop 1
s_cbranch_vccz POK_129
s_sub_u32 s59, s59, 1
s_cbranch_scc1 POK_129
s_sleep 2
buffer_load_dword v3, v14, s[20:23], 0 offen sc1
s_waitcnt vmcnt(0)
s_branch PL_128
POK_129:
buffer_load_dwordx4 v[16:19], v15, s[20:23], s60 offen
s_add_u32 s67, s60, 114688
buffer_load_dwordx4 v[20:23], v15, s[20:23], s67 offen
buffer_load_dwordx4 v[24:27], v15, s[20:23], s61 offen
s_add_u32 s67, s61, 114688
buffer_load_dwordx4 v[28:31], v15, s[20:23], s67 offen
buffer_load_dwordx4 v[32:35], v15, s[20:23], s62 offen
s_add_u32 s67, s62, 114688
buffer_load_dwordx4 v[36:39], v15, s[20:23], s67 offen
buffer_load_dwordx4 v[40:43], v15, s[20:23], s63 offen
s_add_u32 s67, s63, 114688
buffer_load_dwordx4 v[44:47], v15, s[20:23], s67 offen
buffer_load_dwordx4 v[48:51], v15, s[20:23], s64 offen
s_add_u32 s67, s64, 114688
buffer_load_dwordx4 v[52:55], v15, s[20:23], s67 offen
buffer_load_dwordx4 v[56:59], v15, s[20:23], s65 offen
s_add_u32 s67, s65, 114688
buffer_load_dwordx4 v[60:63], v15, s[20:23], s67 offen
buffer_load_dwordx4 v[240:243], v15, s[20:23], s66 offen
s_add_u32 s67, s66, 114688
buffer_load_dwordx4 v[244:247], v15, s[20:23], s67 offen
v_add_u32 v14, 65536, v14
s_waitcnt lgkmcnt(0)
s_mov_b32 s16, s8
s_mov_b32 s17, s9
s_mov_b32 s18, 0x380
s_mov_b32 s19, 0x20000
s_mov_b32 s4, s10
s_mov_b32 s5, s11
s_mov_b32 s6, 0x1c0000
s_mov_b32 s7, 0x20000
v_cmp_ne_u32 vcc, 0, v5
s_cmp_eq_u32 s32, 7
s_cselect_b64 vcc, vcc, 0
v_mov_b32 v8, 0x80000000
s_lshl_b32 s44, s33, 15
v_cndmask_b32 v8, v15, v8, vcc
s_lshl_b32 s38, s32, 12
s_add_u32 s44, s44, s38
s_add_u32 s44, s44, 11534336
s_add_u32 s45, s44, 32768
s_waitcnt vmcnt(12)
v_mfma_f32_32x32x16_bf16 v[64:79], v[128:131], v[16:19], 0
v_mfma_f32_32x32x16_bf16 v[80:95], v[132:135], v[16:19], 0
v_mfma_f32_32x32x16_bf16 v[96:111], v[128:131], v[20:23], 0
v_mfma_f32_32x32x16_bf16 v[112:127], v[132:135], v[20:23], 0
buffer_load_dword v7, v14, s[20:23], 0 offen sc1
s_waitcnt vmcnt(11)
v_mfma_f32_32x32x16_bf16 v[64:79], v[136:139], v[24:27], v[64:79]
v_mfma_f32_32x32x16_bf16 v[80:95], v[140:143], v[24:27], v[80:95]
v_mfma_f32_32x32x16_bf16 v[96:111], v[136:139], v[28:31], v[96:111]
v_mfma_f32_32x32x16_bf16 v[112:127], v[140:143], v[28:31], v[112:127]
s_waitcnt vmcnt(9)
v_mfma_f32_32x32x16_bf16 v[64:79], v[144:147], v[32:35], v[64:79]
v_mfma_f32_32x32x16_bf16 v[80:95], v[148:151], v[32:35], v[80:95]
v_mfma_f32_32x32x16_bf16 v[96:111], v[144:147], v[36:39], v[96:111]
v_mfma_f32_32x32x16_bf16 v[112:127], v[148:151], v[36:39], v[112:127]
s_waitcnt vmcnt(0)
PL_130:
v_cmp_ne_u32 vcc, 1, v7
s_nop 1
s_cbranch_vccz POK_131
s_sub_u32 s59, s59, 1
s_cbranch_scc1 POK_131
s_sleep 2
buffer_load_dword v7, v14, s[20:23], 0 offen sc1
s_waitcnt vmcnt(0)
s_branch PL_130
POK_131:
s_add_u32 s67, s60, 4096
buffer_load_dwordx4 v[248:251], v15, s[20:23], s67 offen
s_add_u32 s67, s60, 118784
buffer_load_dwordx4 v[252:255], v15, s[20:23], s67 offen
s_add_u32 s67, s61, 4096
buffer_load_dwordx4 v[16:19], v15, s[20:23], s67 offen
s_add_u32 s67, s61, 118784
buffer_load_dwordx4 v[20:23], v15, s[20:23], s67 offen
s_add_u32 s67, s62, 4096
buffer_load_dwordx4 v[24:27], v15, s[20:23], s67 offen
s_add_u32 s67, s62, 118784
buffer_load_dwordx4 v[28:31], v15, s[20:23], s67 offen
s_add_u32 s67, s63, 4096
buffer_load_dwordx4 v[32:35], v15, s[20:23], s67 offen
s_add_u32 s67, s63, 118784
buffer_load_dwordx4 v[36:39], v15, s[20:23], s67 offen
s_waitcnt vmcnt(15)
v_mfma_f32_32x32x16_bf16 v[64:79], v[152:155], v[40:43], v[64:79]
v_mfma_f32_32x32x16_bf16 v[80:95], v[156:159], v[40:43], v[80:95]
v_mfma_f32_32x32x16_bf16 v[96:111], v[152:155], v[44:47], v[96:111]
v_mfma_f32_32x32x16_bf16 v[112:127], v[156:159], v[44:47], v[112:127]
s_lshl_b32 s38, s35, 6
s_add_u32 s38, s38, 0
v_add_u32 v2, s38, v5
v_cvt_f32_u32 v2, v2
s_lshl_b32 s38, s32, 5
v_lshl_add_u32 v4, v6, 2, s38
v_cvt_f32_u32 v4, v4
v_mul_f32 v2, 0x3b124925, v2
v_mul_f32 v4, v4, v2
v_fmamk_f32 v128, v2, 0x00000000, v4
v_fmamk_f32 v129, v2, 0x3f800000, v4
v_fmamk_f32 v130, v2, 0x40000000, v4
v_fmamk_f32 v131, v2, 0x40400000, v4
v_sin_f32 v9, v128
v_sin_f32 v10, v129
v_sin_f32 v11, v130
v_sin_f32 v12, v131
v_cos_f32 v128, v128
v_cos_f32 v129, v129
v_cos_f32 v130, v130
v_cos_f32 v131, v131
s_nop 0
v_cvt_pk_bf16_f32 v128, v128, -v9
v_cvt_pk_bf16_f32 v129, v129, -v10
v_cvt_pk_bf16_f32 v130, v130, -v11
v_cvt_pk_bf16_f32 v131, v131, -v12
s_waitcnt vmcnt(13)
v_mfma_f32_32x32x16_bf16 v[64:79], v[160:163], v[48:51], v[64:79]
v_mfma_f32_32x32x16_bf16 v[80:95], v[164:167], v[48:51], v[80:95]
v_mfma_f32_32x32x16_bf16 v[96:111], v[160:163], v[52:55], v[96:111]
v_mfma_f32_32x32x16_bf16 v[112:127], v[164:167], v[52:55], v[112:127]
v_fmamk_f32 v132, v2, 0x41000000, v4
v_fmamk_f32 v133, v2, 0x41100000, v4
v_fmamk_f32 v134, v2, 0x41200000, v4
v_fmamk_f32 v135, v2, 0x41300000, v4
v_sin_f32 v9, v132
v_sin_f32 v10, v133
v_sin_f32 v11, v134
v_sin_f32 v12, v135
v_cos_f32 v132, v132
v_cos_f32 v133, v133
v_cos_f32 v134, v134
v_cos_f32 v135, v135
s_nop 0
v_cvt_pk_bf16_f32 v132, v132, -v9
v_cvt_pk_bf16_f32 v133, v133, -v10
v_cvt_pk_bf16_f32 v134, v134, -v11
v_cvt_pk_bf16_f32 v135, v135, -v12
v_fmamk_f32 v136, v2, 0x41800000, v4
v_fmamk_f32 v137, v2, 0x41880000, v4
v_fmamk_f32 v138, v2, 0x41900000, v4
v_fmamk_f32 v139, v2, 0x41980000, v4
v_sin_f32 v9, v136
v_sin_f32 v10, v137
v_sin_f32 v11, v138
v_sin_f32 v12, v139
v_cos_f32 v136, v136
v_cos_f32 v137, v137
v_cos_f32 v138, v138
v_cos_f32 v139, v139
s_nop 0
v_cvt_pk_bf16_f32 v136, v136, -v9
v_cvt_pk_bf16_f32 v137, v137, -v10
v_cvt_pk_bf16_f32 v138, v138, -v11
v_cvt_pk_bf16_f32 v139, v139, -v12
s_waitcnt vmcnt(11)
v_mfma_f32_32x32x16_bf16 v[64:79], v[168:171], v[56:59], v[64:79]
v_mfma_f32_32x32x16_bf16 v[80:95], v[172:175], v[56:59], v[80:95]
v_mfma_f32_32x32x16_bf16 v[96:111], v[168:171], v[60:63], v[96:111]
v_mfma_f32_32x32x16_bf16 v[112:127], v[172:175], v[60:63], v[112:127]
v_fmamk_f32 v140, v2, 0x41c00000, v4
v_fmamk_f32 v141, v2, 0x41c80000, v4
v_fmamk_f32 v142, v2, 0x41d00000, v4
v_fmamk_f32 v143, v2, 0x41d80000, v4
v_sin_f32 v9, v140
v_sin_f32 v10, v141
v_sin_f32 v11, v142
v_sin_f32 v12, v143
v_cos_f32 v140, v140
v_cos_f32 v141, v141
v_cos_f32 v142, v142
v_cos_f32 v143, v143
s_nop 0
v_cvt_pk_bf16_f32 v140, v140, -v9
v_cvt_pk_bf16_f32 v141, v141, -v10
v_cvt_pk_bf16_f32 v142, v142, -v11
v_cvt_pk_bf16_f32 v143, v143, -v12
s_lshl_b32 s38, s35, 6
s_add_u32 s38, s38, 32
v_add_u32 v2, s38, v5
v_cvt_f32_u32 v2, v2
s_lshl_b32 s38, s32, 5
v_lshl_add_u32 v4, v6, 2, s38
v_cvt_f32_u32 v4, v4
v_mul_f32 v2, 0x3b124925, v2
v_mul_f32 v4, v4, v2
v_fmamk_f32 v144, v2, 0x00000000, v4
v_fmamk_f32 v145, v2, 0x3f800000, v4
v_fmamk_f32 v146, v2, 0x40000000, v4
v_fmamk_f32 v147, v2, 0x40400000, v4
v_sin_f32 v9, v144
v_sin_f32 v10, v145
v_sin_f32 v11, v146
v_sin_f32 v12, v147
v_cos_f32 v144, v144
v_cos_f32 v145, v145
v_cos_f32 v146, v146
v_cos_f32 v147, v147
s_nop 0
v_cvt_pk_bf16_f32 v144, v144, -v9
v_cvt_pk_bf16_f32 v145, v145, -v10
v_cvt_pk_bf16_f32 v146, v146, -v11
v_cvt_pk_bf16_f32 v147, v147, -v12
s_waitcnt vmcnt(9)
v_mfma_f32_32x32x16_bf16 v[64:79], v[176:179], v[240:243], v[64:79]
v_mfma_f32_32x32x16_bf16 v[80:95], v[180:183], v[240:243], v[80:95]
v_mfma_f32_32x32x16_bf16 v[96:111], v[176:179], v[244:247], v[96:111]
v_mfma_f32_32x32x16_bf16 v[112:127], v[180:183], v[244:247], v[112:127]
v_fmamk_f32 v148, v2, 0x41000000, v4
v_fmamk_f32 v149, v2, 0x41100000, v4
v_fmamk_f32 v150, v2, 0x41200000, v4
v_fmamk_f32 v151, v2, 0x41300000, v4
v_sin_f32 v9, v148
v_sin_f32 v10, v149
v_sin_f32 v11, v150
v_sin_f32 v12, v151
v_cos_f32 v148, v148
v_cos_f32 v149, v149
v_cos_f32 v150, v150
v_cos_f32 v151, v151
s_nop 0
v_cvt_pk_bf16_f32 v148, v148, -v9
v_cvt_pk_bf16_f32 v149, v149, -v10
v_cvt_pk_bf16_f32 v150, v150, -v11
v_cvt_pk_bf16_f32 v151, v151, -v12
s_waitcnt vmcnt(6)
v_mfma_f32_32x32x16_bf16 v[64:79], v[184:187], v[248:251], v[64:79]
v_mfma_f32_32x32x16_bf16 v[80:95], v[188:191], v[248:251], v[80:95]
v_mfma_f32_32x32x16_bf16 v[96:111], v[184:187], v[252:255], v[96:111]
v_mfma_f32_32x32x16_bf16 v[112:127], v[188:191], v[252:255], v[112:127]
buffer_load_dwordx4 v[160:163], v8, s[20:23], s44 offen offset:0 sc1
buffer_load_dwordx4 v[164:167], v8, s[20:23], s44 offen offset:1024 sc1
buffer_load_dwordx4 v[168:171], v8, s[20:23], s44 offen offset:2048 sc1
buffer_load_dwordx4 v[172:175], v8, s[20:23], s44 offen offset:3072 sc1
buffer_load_dwordx4 v[176:179], v8, s[20:23], s45 offen offset:0 sc1
buffer_load_dwordx4 v[180:183], v8, s[20:23], s45 offen offset:1024 sc1
buffer_load_dwordx4 v[184:187], v8, s[20:23], s45 offen offset:2048 sc1
buffer_load_dwordx4 v[188:191], v8, s[20:23], s45 offen offset:3072 sc1
s_add_u32 s67, s64, 4096
buffer_load_dwordx4 v[40:43], v15, s[20:23], s67 offen
s_add_u32 s67, s64, 118784
buffer_load_dwordx4 v[44:47], v15, s[20:23], s67 offen
s_add_u32 s67, s65, 4096
buffer_load_dwordx4 v[48:51], v15, s[20:23], s67 offen
s_add_u32 s67, s65, 118784
buffer_load_dwordx4 v[52:55], v15, s[20:23], s67 offen
s_add_u32 s67, s66, 4096
buffer_load_dwordx4 v[56:59], v15, s[20:23], s67 offen
s_add_u32 s67, s66, 118784
buffer_load_dwordx4 v[60:63], v15, s[20:23], s67 offen
v_fmamk_f32 v152, v2, 0x41800000, v4
v_fmamk_f32 v153, v2, 0x41880000, v4
v_fmamk_f32 v154, v2, 0x41900000, v4
v_fmamk_f32 v155, v2, 0x41980000, v4
v_sin_f32 v9, v152
v_sin_f32 v10, v153
v_sin_f32 v11, v154
v_sin_f32 v12, v155
v_cos_f32 v152, v152
v_cos_f32 v153, v153
v_cos_f32 v154, v154
v_cos_f32 v155, v155
s_nop 0
v_cvt_pk_bf16_f32 v152, v152, -v9
v_cvt_pk_bf16_f32 v153, v153, -v10
v_cvt_pk_bf16_f32 v154, v154, -v11
v_cvt_pk_bf16_f32 v155, v155, -v12
s_waitcnt vmcnt(18)
v_mfma_f32_32x32x16_bf16 v[64:79], v[192:195], v[16:19], v[64:79]
v_mfma_f32_32x32x16_bf16 v[80:95], v[196:199], v[16:19], v[80:95]
v_mfma_f32_32x32x16_bf16 v[96:111], v[192:195], v[20:23], v[96:111]
v_mfma_f32_32x32x16_bf16 v[112:127], v[196:199], v[20:23], v[112:127]
v_fmamk_f32 v156, v2, 0x41c00000, v4
v_fmamk_f32 v157, v2, 0x41c80000, v4
v_fmamk_f32 v158, v2, 0x41d00000, v4
v_fmamk_f32 v159, v2, 0x41d80000, v4
v_sin_f32 v9, v156
v_sin_f32 v10, v157
v_sin_f32 v11, v158
v_sin_f32 v12, v159
v_cos_f32 v156, v156
v_cos_f32 v157, v157
v_cos_f32 v158, v158
v_cos_f32 v159, v159
s_nop 0
v_cvt_pk_bf16_f32 v156, v156, -v9
v_cvt_pk_bf16_f32 v157, v157, -v10
v_cvt_pk_bf16_f32 v158, v158, -v11
v_cvt_pk_bf16_f32 v159, v159, -v12
s_waitcnt vmcnt(16)
v_mfma_f32_32x32x16_bf16 v[64:79], v[200:203], v[24:27], v[64:79]
v_mfma_f32_32x32x16_bf16 v[80:95], v[204:207], v[24:27], v[80:95]
v_mfma_f32_32x32x16_bf16 v[96:111], v[200:203], v[28:31], v[96:111]
v_mfma_f32_32x32x16_bf16 v[112:127], v[204:207], v[28:31], v[112:127]
v_and_b32 v9, 15, v5
v_xor_b32 v9, v9, v6
v_lshlrev_b32 v9, 4, v9
v_lshl_add_u32 v9, v5, 8, v9
s_lshl_b32 s38, s32, 14
v_add_u32 v9, s38, v9
s_lshl_b32 s38, s32, 3
v_lshrrev_b32 v10, 3, v0
v_add_u32 v10, s38, v10
v_and_b32 v11, 7, v0
v_and_b32 v12, 31, v10
v_lshrrev_b32 v13, 5, v10
v_lshl_add_u32 v12, v12, 6, v13
v_add_u32 v12, s33, v12
v_mul_u32_u24 v12, 896, v12
s_lshl_b32 s38, s35, 7
v_lshl_add_u32 v13, v11, 4, s38
v_add_u32 v12, v12, v13
v_and_b32 v7, 15, v10
v_lshlrev_b32 v11, 1, v11
v_xor_b32 v11, v11, v7
v_lshlrev_b32 v11, 4, v11
v_lshl_add_u32 v10, v10, 8, v11
s_waitcnt vmcnt(14)
v_mfma_f32_32x32x16_bf16 v[64:79], v[208:211], v[32:35], v[64:79]
v_mfma_f32_32x32x16_bf16 v[80:95], v[212:215], v[32:35], v[80:95]
v_mfma_f32_32x32x16_bf16 v[96:111], v[208:211], v[36:39], v[96:111]
v_mfma_f32_32x32x16_bf16 v[112:127], v[212:215], v[36:39], v[112:127]
ds_read_b128 v[192:195], v1 offset:0
ds_read_b128 v[196:199], v1 offset:1024
ds_read_b128 v[200:203], v1 offset:2048
ds_read_b128 v[204:207], v1 offset:3072
ds_read_b128 v[208:211], v1 offset:4096
ds_read_b128 v[212:215], v1 offset:5120
ds_read_b128 v[32:35], v1 offset:6144
ds_read_b128 v[36:39], v1 offset:7168
s_waitcnt vmcnt(10)
CK_132:
v_max_u32 v3, v160, v161
v_max3_u32 v3, v3, v162, v163
v_max3_u32 v3, v3, v164, v165
v_max3_u32 v3, v3, v166, v167
v_max3_u32 v3, v3, v168, v169
v_max3_u32 v3, v3, v170, v171
v_max3_u32 v3, v3, v172, v173
v_max3_u32 v3, v3, v174, v175
v_cmp_eq_u32 vcc, -1, v3
s_nop 1
s_cbranch_vccz CKOK_133
s_sub_u32 s59, s59, 1
s_cbranch_scc1 CKOK_133
s_sleep 2
buffer_load_dwordx4 v[160:163], v8, s[20:23], s44 offen offset:0 sc1
buffer_load_dwordx4 v[164:167], v8, s[20:23], s44 offen offset:1024 sc1
buffer_load_dwordx4 v[168:171], v8, s[20:23], s44 offen offset:2048 sc1
buffer_load_dwordx4 v[172:175], v8, s[20:23], s44 offen offset:3072 sc1
s_waitcnt vmcnt(0)
s_branch CK_132
CKOK_133:
s_waitcnt lgkmcnt(6)
v_mfma_f32_32x32x16_bf16 v[240:255], v[160:163], v[192:195], 0
v_mfma_f32_32x32x16_bf16 v[16:31], v[160:163], v[196:199], 0
s_waitcnt lgkmcnt(4)
v_mfma_f32_32x32x16_bf16 v[240:255], v[164:167], v[200:203], v[240:255]
v_mfma_f32_32x32x16_bf16 v[16:31], v[164:167], v[204:207], v[16:31]
s_waitcnt lgkmcnt(2)
v_mfma_f32_32x32x16_bf16 v[240:255], v[168:171], v[208:211], v[240:255]
v_mfma_f32_32x32x16_bf16 v[16:31], v[168:171], v[212:215], v[16:31]
s_waitcnt lgkmcnt(0)
v_mfma_f32_32x32x16_bf16 v[240:255], v[172:175], v[32:35], v[240:255]
v_mfma_f32_32x32x16_bf16 v[16:31], v[172:175], v[36:39], v[16:31]
ds_read_b128 v[192:195], v1 offset:8192
ds_read_b128 v[196:199], v1 offset:9216
ds_read_b128 v[200:203], v1 offset:10240
ds_read_b128 v[204:207], v1 offset:11264
ds_read_b128 v[208:211], v1 offset:12288
ds_read_b128 v[212:215], v1 offset:13312
ds_read_b128 v[32:35], v1 offset:14336
ds_read_b128 v[36:39], v1 offset:15360
s_nop 7
v_cvt_pk_bf16_f32 v160, v240, v16
v_cvt_pk_bf16_f32 v161, v241, v17
v_cvt_pk_bf16_f32 v162, v242, v18
v_cvt_pk_bf16_f32 v163, v243, v19
v_cvt_pk_bf16_f32 v164, v244, v20
v_cvt_pk_bf16_f32 v165, v245, v21
v_cvt_pk_bf16_f32 v166, v246, v22
v_cvt_pk_bf16_f32 v167, v247, v23
v_cvt_pk_bf16_f32 v168, v248, v24
v_cvt_pk_bf16_f32 v169, v249, v25
v_cvt_pk_bf16_f32 v170, v250, v26
v_cvt_pk_bf16_f32 v171, v251, v27
v_cvt_pk_bf16_f32 v172, v252, v28
v_cvt_pk_bf16_f32 v173, v253, v29
v_cvt_pk_bf16_f32 v174, v254, v30
v_cvt_pk_bf16_f32 v175, v255, v31
s_nop 1
v_mfma_f32_32x32x16_bf16 v[64:79], v[128:131], v[160:163], v[64:79]
v_mfma_f32_32x32x16_bf16 v[80:95], v[144:147], v[160:163], v[80:95]
v_mfma_f32_32x32x16_bf16 v[64:79], v[132:135], v[164:167], v[64:79]
v_mfma_f32_32x32x16_bf16 v[80:95], v[148:151], v[164:167], v[80:95]
v_mfma_f32_32x32x16_bf16 v[64:79], v[136:139], v[168:171], v[64:79]
v_mfma_f32_32x32x16_bf16 v[80:95], v[152:155], v[168:171], v[80:95]
v_mfma_f32_32x32x16_bf16 v[64:79], v[140:143], v[172:175], v[64:79]
v_mfma_f32_32x32x16_bf16 v[80:95], v[156:159], v[172:175], v[80:95]
s_waitcnt vmcnt(6)
CK_134:
v_max_u32 v3, v176, v177
v_max3_u32 v3, v3, v178, v179
v_max3_u32 v3, v3, v180, v181
v_max3_u32 v3, v3, v182, v183
v_max3_u32 v3, v3, v184, v185
v_max3_u32 v3, v3, v186, v187
v_max3_u32 v3, v3, v188, v189
v_max3_u32 v3, v3, v190, v191
v_cmp_eq_u32 vcc, -1, v3
s_nop 1
s_cbranch_vccz CKOK_135
s_sub_u32 s59, s59, 1
s_cbranch_scc1 CKOK_135
s_sleep 2
buffer_load_dwordx4 v[176:179], v8, s[20:23], s45 offen offset:0 sc1
buffer_load_dwordx4 v[180:183], v8, s[20:23], s45 offen offset:1024 sc1
buffer_load_dwordx4 v[184:187], v8, s[20:23], s45 offen offset:2048 sc1
buffer_load_dwordx4 v[188:191], v8, s[20:23], s45 offen offset:3072 sc1
s_waitcnt vmcnt(0)
s_branch CK_134
CKOK_135:
s_waitcnt lgkmcnt(6)
v_mfma_f32_32x32x16_bf16 v[240:255], v[176:179], v[192:195], 0
v_mfma_f32_32x32x16_bf16 v[16:31], v[176:179], v[196:199], 0
s_waitcnt lgkmcnt(4)
v_mfma_f32_32x32x16_bf16 v[240:255], v[180:183], v[200:203], v[240:255]
v_mfma_f32_32x32x16_bf16 v[16:31], v[180:183], v[204:207], v[16:31]
s_waitcnt lgkmcnt(2)
v_mfma_f32_32x32x16_bf16 v[240:255], v[184:187], v[208:211], v[240:255]
v_mfma_f32_32x32x16_bf16 v[16:31], v[184:187], v[212:215], v[16:31]
s_waitcnt lgkmcnt(0)
v_mfma_f32_32x32x16_bf16 v[240:255], v[188:191], v[32:35], v[240:255]
v_mfma_f32_32x32x16_bf16 v[16:31], v[188:191], v[36:39], v[16:31]
buffer_load_dwordx4 v[192:195], v12, s[12:15], 0 offen
buffer_load_dwordx4 v[196:199], v13, s[16:19], 0 offen
s_nop 7
s_nop 3
v_cvt_pk_bf16_f32 v176, v240, v16
v_cvt_pk_bf16_f32 v177, v241, v17
v_cvt_pk_bf16_f32 v178, v242, v18
v_cvt_pk_bf16_f32 v179, v243, v19
v_cvt_pk_bf16_f32 v180, v244, v20
v_cvt_pk_bf16_f32 v181, v245, v21
v_cvt_pk_bf16_f32 v182, v246, v22
v_cvt_pk_bf16_f32 v183, v247, v23
v_cvt_pk_bf16_f32 v184, v248, v24
v_cvt_pk_bf16_f32 v185, v249, v25
v_cvt_pk_bf16_f32 v186, v250, v26
v_cvt_pk_bf16_f32 v187, v251, v27
v_cvt_pk_bf16_f32 v188, v252, v28
v_cvt_pk_bf16_f32 v189, v253, v29
v_cvt_pk_bf16_f32 v190, v254, v30
v_cvt_pk_bf16_f32 v191, v255, v31
s_nop 1
v_mfma_f32_32x32x16_bf16 v[96:111], v[128:131], v[176:179], v[96:111]
v_mfma_f32_32x32x16_bf16 v[112:127], v[144:147], v[176:179], v[112:127]
v_mfma_f32_32x32x16_bf16 v[96:111], v[132:135], v[180:183], v[96:111]
v_mfma_f32_32x32x16_bf16 v[112:127], v[148:151], v[180:183], v[112:127]
v_mfma_f32_32x32x16_bf16 v[96:111], v[136:139], v[184:187], v[96:111]
v_mfma_f32_32x32x16_bf16 v[112:127], v[152:155], v[184:187], v[112:127]
v_mfma_f32_32x32x16_bf16 v[96:111], v[140:143], v[188:191], v[96:111]
v_mfma_f32_32x32x16_bf16 v[112:127], v[156:159], v[188:191], v[112:127]
s_waitcnt vmcnt(6)
v_mfma_f32_32x32x16_bf16 v[64:79], v[216:219], v[40:43], v[64:79]
v_mfma_f32_32x32x16_bf16 v[80:95], v[220:223], v[40:43], v[80:95]
v_mfma_f32_32x32x16_bf16 v[96:111], v[216:219], v[44:47], v[96:111]
v_mfma_f32_32x32x16_bf16 v[112:127], v[220:223], v[44:47], v[112:127]
s_waitcnt vmcnt(4)
v_mfma_f32_32x32x16_bf16 v[64:79], v[224:227], v[48:51], v[64:79]
v_mfma_f32_32x32x16_bf16 v[80:95], v[228:231], v[48:51], v[80:95]
v_mfma_f32_32x32x16_bf16 v[96:111], v[224:227], v[52:55], v[96:111]
v_mfma_f32_32x32x16_bf16 v[112:127], v[228:231], v[52:55], v[112:127]
s_waitcnt vmcnt(2)
v_mfma_f32_32x32x16_bf16 v[64:79], v[232:235], v[56:59], v[64:79]
v_mfma_f32_32x32x16_bf16 v[80:95], v[236:239], v[56:59], v[80:95]
v_mfma_f32_32x32x16_bf16 v[96:111], v[232:235], v[60:63], v[96:111]
v_mfma_f32_32x32x16_bf16 v[112:127], v[236:239], v[60:63], v[112:127]
v_xor_b32 v17, 32, v9
v_xor_b32 v18, 64, v9
v_xor_b32 v19, 96, v9
v_xor_b32 v20, 128, v9
v_xor_b32 v21, 160, v9
v_xor_b32 v22, 192, v9
v_xor_b32 v23, 224, v9
v_mov_b32 v16, v9
s_nop 3
ds_write_b128 v16, v[64:67] offset:0
ds_write_b128 v17, v[68:71] offset:0
ds_write_b128 v18, v[72:75] offset:0
ds_write_b128 v19, v[76:79] offset:0
ds_write_b128 v20, v[80:83] offset:0
ds_write_b128 v21, v[84:87] offset:0
ds_write_b128 v22, v[88:91] offset:0
ds_write_b128 v23, v[92:95] offset:0
ds_write_b128 v16, v[96:99] offset:8192
ds_write_b128 v17, v[100:103] offset:8192
ds_write_b128 v18, v[104:107] offset:8192
ds_write_b128 v19, v[108:111] offset:8192
ds_write_b128 v20, v[112:115] offset:8192
ds_write_b128 v21, v[116:119] offset:8192
ds_write_b128 v22, v[120:123] offset:8192
ds_write_b128 v23, v[124:127] offset:8192
v_xor_b32 v5, 16, v10
v_add_u32 v7, 65536, v10
v_add_u32 v8, 65536, v5
s_waitcnt vmcnt(0)
v_lshlrev_b32 v32, 16, v192
v_and_b32 v33, 0xffff0000, v192
v_lshlrev_b32 v40, 16, v196
v_and_b32 v41, 0xffff0000, v196
v_lshlrev_b32 v34, 16, v193
v_and_b32 v35, 0xffff0000, v193
v_lshlrev_b32 v42, 16, v197
v_and_b32 v43, 0xffff0000, v197
v_lshlrev_b32 v36, 16, v194
v_and_b32 v37, 0xffff0000, v194
v_lshlrev_b32 v44, 16, v198
v_and_b32 v45, 0xffff0000, v198
v_lshlrev_b32 v38, 16, v195
v_and_b32 v39, 0xffff0000, v195
v_lshlrev_b32 v46, 16, v199
v_and_b32 v47, 0xffff0000, v199
v_add_f32 v32, v32, v40
v_add_f32 v33, v33, v41
v_add_f32 v34, v34, v42
v_add_f32 v35, v35, v43
v_add_f32 v36, v36, v44
v_add_f32 v37, v37, v45
v_add_f32 v38, v38, v46
v_add_f32 v39, v39, v47
s_waitcnt lgkmcnt(0)
s_barrier
ds_read_b128 v[128:131], v10 offset:0
ds_read_b128 v[132:135], v5 offset:0
ds_read_b128 v[136:139], v10 offset:16384
ds_read_b128 v[140:143], v5 offset:16384
ds_read_b128 v[144:147], v10 offset:32768
ds_read_b128 v[148:151], v5 offset:32768
ds_read_b128 v[152:155], v10 offset:49152
ds_read_b128 v[156:159], v5 offset:49152
ds_read_b128 v[160:163], v7 offset:0
ds_read_b128 v[164:167], v8 offset:0
ds_read_b128 v[168:171], v7 offset:16384
ds_read_b128 v[172:175], v8 offset:16384
ds_read_b128 v[176:179], v7 offset:32768
ds_read_b128 v[180:183], v8 offset:32768
ds_read_b128 v[184:187], v7 offset:49152
ds_read_b128 v[188:191], v8 offset:49152
s_waitcnt lgkmcnt(14)
v_add_f32 v32, v32, v128
v_add_f32 v33, v33, v129
v_add_f32 v34, v34, v130
v_add_f32 v35, v35, v131
v_add_f32 v36, v36, v132
v_add_f32 v37, v37, v133
v_add_f32 v38, v38, v134
v_add_f32 v39, v39, v135
s_waitcnt lgkmcnt(12)
v_add_f32 v32, v32, v136
v_add_f32 v33, v33, v137
v_add_f32 v34, v34, v138
v_add_f32 v35, v35, v139
v_add_f32 v36, v36, v140
v_add_f32 v37, v37, v141
v_add_f32 v38, v38, v142
v_add_f32 v39, v39, v143
s_waitcnt lgkmcnt(10)
v_add_f32 v32, v32, v144
v_add_f32 v33, v33, v145
v_add_f32 v34, v34, v146
v_add_f32 v35, v35, v147
v_add_f32 v36, v36, v148
v_add_f32 v37, v37, v149
v_add_f32 v38, v38, v150
v_add_f32 v39, v39, v151
s_waitcnt lgkmcnt(8)
v_add_f32 v32, v32, v152
v_add_f32 v33, v33, v153
v_add_f32 v34, v34, v154
v_add_f32 v35, v35, v155
v_add_f32 v36, v36, v156
v_add_f32 v37, v37, v157
v_add_f32 v38, v38, v158
v_add_f32 v39, v39, v159
s_waitcnt lgkmcnt(6)
v_add_f32 v32, v32, v160
v_add_f32 v33, v33, v161
v_add_f32 v34, v34, v162
v_add_f32 v35, v35, v163
v_add_f32 v36, v36, v164
v_add_f32 v37, v37, v165
v_add_f32 v38, v38, v166
v_add_f32 v39, v39, v167
s_waitcnt lgkmcnt(4)
v_add_f32 v32, v32, v168
v_add_f32 v33, v33, v169
v_add_f32 v34, v34, v170
v_add_f32 v35, v35, v171
v_add_f32 v36, v36, v172
v_add_f32 v37, v37, v173
v_add_f32 v38, v38, v174
v_add_f32 v39, v39, v175
s_waitcnt lgkmcnt(2)
v_add_f32 v32, v32, v176
v_add_f32 v33, v33, v177
v_add_f32 v34, v34, v178
v_add_f32 v35, v35, v179
v_add_f32 v36, v36, v180
v_add_f32 v37, v37, v181
v_add_f32 v38, v38, v182
v_add_f32 v39, v39, v183
s_waitcnt lgkmcnt(0)
v_add_f32 v32, v32, v184
v_add_f32 v33, v33, v185
v_add_f32 v34, v34, v186
v_add_f32 v35, v35, v187
v_add_f32 v36, v36, v188
v_add_f32 v37, v37, v189
v_add_f32 v38, v38, v190
v_add_f32 v39, v39, v191
v_cvt_pk_bf16_f32 v40, v32, v33
v_cvt_pk_bf16_f32 v41, v34, v35
v_cvt_pk_bf16_f32 v42, v36, v37
v_cvt_pk_bf16_f32 v43, v38, v39
buffer_store_dwordx4 v[40:43], v12, s[4:7], 0 offen
s_endpgm
K1SPARE_2:
s_sub_u32 s48, s43, 28
s_lshl_b32 s48, s48, 3
s_add_u32 s48, s48, s42
s_lshr_b32 s47, s48, 1
s_lshl_b32 s47, s47, 4
s_and_b32 s33, s48, 1
s_add_u32 s47, s47, s33
s_add_u32 s46, s47, 14
s_lshl_b32 s47, s46, 8
s_add_u32 s47, s47, 13631488
s_waitcnt lgkmcnt(0)
s_mov_b32 s12, s6
s_mov_b32 s13, s7
s_mov_b32 s14, 0x188000
s_mov_b32 s15, 0x20000
s_mov_b32 s20, s30
s_mov_b32 s21, s31
s_mov_b32 s22, 0xd40000
s_mov_b32 s23, 0x20000
s_mov_b32 s24, s28
s_mov_b32 s25, s29
s_mov_b32 s26, 0x100
s_mov_b32 s27, 0x20000
v_and_b32 v2, 15, v0
v_lshrrev_b32 v3, 4, v0
v_lshlrev_b32 v4, 4, v0
v_mul_u32_u24 v5, 57600, v3
v_lshlrev_b32 v244, 15, v3
v_lshl_add_u32 v244, v2, 4, v244
v_lshrrev_b32 v245, 2, v2
v_lshlrev_b32 v245, 9, v245
v_and_b32 v8, 3, v2
v_lshl_add_u32 v245, v8, 2, v245
v_lshl_add_u32 v245, v3, 17, v245
s_and_b32 s49, s32, 3
s_lshr_b32 s38, s32, 2
s_lshr_b32 s50, s48, 3
s_lshl_b32 s50, s50, 2
s_add_u32 s50, s50, s38
s_lshl_b32 s50, s50, 3
s_and_b32 s38, s48, 7
s_add_u32 s50, s50, s38
s_add_u32 s51, s50, 16
s_lshr_b32 s33, s50, 3
s_and_b32 s34, s50, 7
s_lshl_b32 s35, s34, 2
s_add_u32 s35, s35, s49
s_lshl_b32 s36, s33, 5
s_add_u32 s36, s36, s35
s_lshl_b32 s36, s36, 12
s_add_u32 s52, s36, 9437184
s_mul_i32 s37, s35, 450
s_lshl_b32 s38, s33, 5
s_add_u32 s37, s37, s38
v_lshl_add_u32 v6, v2, 1, v5
v_add_u32 v6, s37, v6
s_lshl_b32 s38, s49, 19
s_lshr_b32 s39, s33, 1
s_lshl_b32 s39, s39, 12
s_add_u32 s38, s38, s39
s_lshl_b32 s39, s34, 9
s_add_u32 s38, s38, s39
s_and_b32 s39, s33, 1
s_lshl_b32 s39, s39, 8
s_add_u32 s38, s38, s39
s_add_u32 s54, s38, 11534336
s_lshr_b32 s33, s51, 3
s_and_b32 s34, s51, 7
s_lshl_b32 s35, s34, 2
s_add_u32 s35, s35, s49
s_lshl_b32 s36, s33, 5
s_add_u32 s36, s36, s35
s_lshl_b32 s36, s36, 12
s_add_u32 s53, s36, 9437184
s_mul_i32 s37, s35, 450
s_lshl_b32 s38, s33, 5
s_add_u32 s37, s37, s38
v_lshl_add_u32 v7, v2, 1, v5
v_add_u32 v7, s37, v7
s_lshl_b32 s38, s49, 19
s_lshr_b32 s39, s33, 1
s_lshl_b32 s39, s39, 12
s_add_u32 s38, s38, s39
s_lshl_b32 s39, s34, 9
s_add_u32 s38, s38, s39
s_and_b32 s39, s33, 1
s_lshl_b32 s39, s39, 8
s_add_u32 s38, s38, s39
s_add_u32 s55, s38, 11534336
s_mov_b32 s56, 0
s_cmp_lt_u32 s51, 112
s_cbranch_scc1 K2N_136
s_mov_b32 s56, 2
s_cmp_lg_u32 s32, 0
s_cbranch_scc1 K2N_136
s_mov_b32 s56, 1
s_bfe_u32 s57, s48, 0x10002
s_lshl_b32 s53, s57, 12
s_add_u32 s53, s53, 11272192
s_mul_i32 s37, s57, 7200
s_add_u32 s37, s37, 448
v_mul_u32_u24 v7, 450, v2
v_add3_u32 v7, v7, v5, s37
s_and_b32 s37, s48, 3
v_lshrrev_b32 v8, 2, v2
v_cmp_eq_u32 s[68:69], s37, v8
v_bfrev_b32 v8, 1
s_nop 0
v_cndmask_b32 v7, v8, v7, s[68:69]
s_lshl_b32 s38, s57, 11
s_add_u32 s55, s38, 11563008
K2N_136:
s_lshl_b32 s33, s48, 3
s_add_u32 s33, s33, s32
v_lshrrev_b32 v92, 5, v0
v_and_b32 v93, 31, v0
v_mul_u32_u24 v92, 3584, v92
v_lshl_add_u32 v92, v93, 1, v92
v_add_u32 v93, 7168, v92
v_mov_b32 v248, 0
v_mov_b32 v249, 0
v_mov_b32 v250, 0
v_mov_b32 v251, 0
s_lshl_b32 s38, s33, 10
s_add_u32 s38, s38, 13631488
buffer_store_dwordx4 v[248:251], v4, s[20:23], s38 offen sc1
s_add_u32 s34, s33, 0
s_mul_hi_u32 s35, s34, 306783379
s_mul_i32 s36, s35, 14
s_sub_u32 s36, s34, s36
s_mul_i32 s37, s35, 14336
s_lshl_b32 s38, s36, 6
s_add_u32 s37, s37, s38
s_mul_i32 s38, s36, 112
s_add_u32 s38, s38, s35
s_lshl_b32 s38, s38, 10
s_add_u32 s60, s38, 7340032
buffer_load_ushort v8, v92, s[12:15], s37 offen offset:0
buffer_load_ushort v9, v92, s[12:15], s37 offen offset:896
buffer_load_ushort v10, v92, s[12:15], s37 offen offset:1792
buffer_load_ushort v11, v92, s[12:15], s37 offen offset:2688
buffer_load_ushort v12, v93, s[12:15], s37 offen offset:0
buffer_load_ushort v13, v93, s[12:15], s37 offen offset:896
buffer_load_ushort v14, v93, s[12:15], s37 offen offset:1792
buffer_load_ushort v15, v93, s[12:15], s37 offen offset:2688
s_add_u32 s34, s33, 256
s_mul_hi_u32 s35, s34, 306783379
s_mul_i32 s36, s35, 14
s_sub_u32 s36, s34, s36
s_mul_i32 s37, s35, 14336
s_lshl_b32 s38, s36, 6
s_add_u32 s37, s37, s38
s_mul_i32 s38, s36, 112
s_add_u32 s38, s38, s35
s_lshl_b32 s38, s38, 10
s_add_u32 s61, s38, 7340032
buffer_load_ushort v16, v92, s[12:15], s37 offen offset:0
buffer_load_ushort v17, v92, s[12:15], s37 offen offset:896
buffer_load_ushort v18, v92, s[12:15], s37 offen offset:1792
buffer_load_ushort v19, v92, s[12:15], s37 offen offset:2688
buffer_load_ushort v20, v93, s[12:15], s37 offen offset:0
buffer_load_ushort v21, v93, s[12:15], s37 offen offset:896
buffer_load_ushort v22, v93, s[12:15], s37 offen offset:1792
buffer_load_ushort v23, v93, s[12:15], s37 offen offset:2688
s_add_u32 s34, s33, 512
s_mul_hi_u32 s35, s34, 306783379
s_mul_i32 s36, s35, 14
s_sub_u32 s36, s34, s36
s_mul_i32 s37, s35, 14336
s_lshl_b32 s38, s36, 6
s_add_u32 s37, s37, s38
s_mul_i32 s38, s36, 112
s_add_u32 s38, s38, s35
s_lshl_b32 s38, s38, 10
s_add_u32 s62, s38, 7340032
buffer_load_ushort v24, v92, s[12:15], s37 offen offset:0
buffer_load_ushort v25, v92, s[12:15], s37 offen offset:896
buffer_load_ushort v26, v92, s[12:15], s37 offen offset:1792
buffer_load_ushort v27, v92, s[12:15], s37 offen offset:2688
buffer_load_ushort v28, v93, s[12:15], s37 offen offset:0
buffer_load_ushort v29, v93, s[12:15], s37 offen offset:896
buffer_load_ushort v30, v93, s[12:15], s37 offen offset:1792
buffer_load_ushort v31, v93, s[12:15], s37 offen offset:2688
s_add_u32 s34, s33, 768
s_mul_hi_u32 s35, s34, 306783379
s_mul_i32 s36, s35, 14
s_sub_u32 s36, s34, s36
s_mul_i32 s37, s35, 14336
s_lshl_b32 s38, s36, 6
s_add_u32 s37, s37, s38
s_mul_i32 s38, s36, 112
s_add_u32 s38, s38, s35
s_lshl_b32 s38, s38, 10
s_add_u32 s63, s38, 7340032
buffer_load_ushort v32, v92, s[12:15], s37 offen offset:0
buffer_load_ushort v33, v92, s[12:15], s37 offen offset:896
buffer_load_ushort v34, v92, s[12:15], s37 offen offset:1792
buffer_load_ushort v35, v92, s[12:15], s37 offen offset:2688
buffer_load_ushort v36, v93, s[12:15], s37 offen offset:0
buffer_load_ushort v37, v93, s[12:15], s37 offen offset:896
buffer_load_ushort v38, v93, s[12:15], s37 offen offset:1792
buffer_load_ushort v39, v93, s[12:15], s37 offen offset:2688
s_add_u32 s34, s33, 1024
s_mul_hi_u32 s35, s34, 306783379
s_mul_i32 s36, s35, 14
s_sub_u32 s36, s34, s36
s_mul_i32 s37, s35, 14336
s_lshl_b32 s38, s36, 6
s_add_u32 s37, s37, s38
s_mul_i32 s38, s36, 112
s_add_u32 s38, s38, s35
s_lshl_b32 s38, s38, 10
s_add_u32 s64, s38, 7340032
buffer_load_ushort v40, v92, s[12:15], s37 offen offset:0
buffer_load_ushort v41, v92, s[12:15], s37 offen offset:896
buffer_load_ushort v42, v92, s[12:15], s37 offen offset:1792
buffer_load_ushort v43, v92, s[12:15], s37 offen offset:2688
buffer_load_ushort v44, v93, s[12:15], s37 offen offset:0
buffer_load_ushort v45, v93, s[12:15], s37 offen offset:896
buffer_load_ushort v46, v93, s[12:15], s37 offen offset:1792
buffer_load_ushort v47, v93, s[12:15], s37 offen offset:2688
s_add_u32 s34, s33, 1280
s_mul_hi_u32 s35, s34, 306783379
s_mul_i32 s36, s35, 14
s_sub_u32 s36, s34, s36
s_mul_i32 s37, s35, 14336
s_lshl_b32 s38, s36, 6
s_add_u32 s37, s37, s38
s_mul_i32 s38, s36, 112
s_add_u32 s38, s38, s35
s_lshl_b32 s38, s38, 10
s_add_u32 s65, s38, 7340032
buffer_load_ushort v48, v92, s[12:15], s37 offen offset:0
buffer_load_ushort v49, v92, s[12:15], s37 offen offset:896
buffer_load_ushort v50, v92, s[12:15], s37 offen offset:1792
buffer_load_ushort v51, v92, s[12:15], s37 offen offset:2688
buffer_load_ushort v52, v93, s[12:15], s37 offen offset:0
buffer_load_ushort v53, v93, s[12:15], s37 offen offset:896
buffer_load_ushort v54, v93, s[12:15], s37 offen offset:1792
buffer_load_ushort v55, v93, s[12:15], s37 offen offset:2688
s_add_u32 s34, s33, 1536
s_mul_hi_u32 s35, s34, 306783379
s_mul_i32 s36, s35, 14
s_sub_u32 s36, s34, s36
s_mul_i32 s37, s35, 14336
s_lshl_b32 s38, s36, 6
s_add_u32 s37, s37, s38
s_mul_i32 s38, s36, 112
s_add_u32 s38, s38, s35
s_lshl_b32 s38, s38, 10
s_add_u32 s66, s38, 7340032
buffer_load_ushort v56, v92, s[12:15], s37 offen offset:0
buffer_load_ushort v57, v92, s[12:15], s37 offen offset:896
buffer_load_ushort v58, v92, s[12:15], s37 offen offset:1792
buffer_load_ushort v59, v92, s[12:15], s37 offen offset:2688
buffer_load_ushort v60, v93, s[12:15], s37 offen offset:0
buffer_load_ushort v61, v93, s[12:15], s37 offen offset:896
buffer_load_ushort v62, v93, s[12:15], s37 offen offset:1792
buffer_load_ushort v63, v93, s[12:15], s37 offen offset:2688
s_waitcnt vmcnt(48)
v_lshl_or_b32 v64, v9, 16, v8
v_lshl_or_b32 v65, v11, 16, v10
v_lshl_or_b32 v66, v13, 16, v12
v_lshl_or_b32 v67, v15, 16, v14
buffer_store_dwordx4 v[64:67], v4, s[20:23], s60 offen sc1
s_waitcnt vmcnt(41)
v_lshl_or_b32 v68, v17, 16, v16
v_lshl_or_b32 v69, v19, 16, v18
v_lshl_or_b32 v70, v21, 16, v20
v_lshl_or_b32 v71, v23, 16, v22
buffer_store_dwordx4 v[68:71], v4, s[20:23], s61 offen sc1
s_waitcnt vmcnt(34)
v_lshl_or_b32 v72, v25, 16, v24
v_lshl_or_b32 v73, v27, 16, v26
v_lshl_or_b32 v74, v29, 16, v28
v_lshl_or_b32 v75, v31, 16, v30
buffer_store_dwordx4 v[72:75], v4, s[20:23], s62 offen sc1
s_waitcnt vmcnt(27)
v_lshl_or_b32 v76, v33, 16, v32
v_lshl_or_b32 v77, v35, 16, v34
v_lshl_or_b32 v78, v37, 16, v36
v_lshl_or_b32 v79, v39, 16, v38
buffer_store_dwordx4 v[76:79], v4, s[20:23], s63 offen sc1
s_waitcnt vmcnt(20)
v_lshl_or_b32 v80, v41, 16, v40
v_lshl_or_b32 v81, v43, 16, v42
v_lshl_or_b32 v82, v45, 16, v44
v_lshl_or_b32 v83, v47, 16, v46
buffer_store_dwordx4 v[80:83], v4, s[20:23], s64 offen sc1
s_waitcnt vmcnt(13)
v_lshl_or_b32 v84, v49, 16, v48
v_lshl_or_b32 v85, v51, 16, v50
v_lshl_or_b32 v86, v53, 16, v52
v_lshl_or_b32 v87, v55, 16, v54
buffer_store_dwordx4 v[84:87], v4, s[20:23], s65 offen sc1
s_cmp_ge_u32 s33, 32
s_cbranch_scc1 W2DONE
s_waitcnt vmcnt(6)
v_lshl_or_b32 v88, v57, 16, v56
v_lshl_or_b32 v89, v59, 16, v58
v_lshl_or_b32 v90, v61, 16, v60
v_lshl_or_b32 v91, v63, 16, v62
buffer_store_dwordx4 v[88:91], v4, s[20:23], s66 offen sc1
W2DONE:
s_mov_b32 s12, s88
s_mov_b32 s13, s89
s_mov_b32 s14, 0xe1000
s_mov_b32 s15, 0x20000
s_mov_b32 s16, s90
s_mov_b32 s17, s91
s_mov_b32 s18, 0xe1000
s_mov_b32 s19, 0x20000
v_mov_b32 v112, 0
v_mov_b32 v116, 0
v_mov_b32 v120, 0
v_mov_b32 v124, 0
v_mov_b32 v8, 1
s_waitcnt vmcnt(0)
s_barrier
s_cmp_lg_u32 s32, 0
s_cbranch_scc1 W2SIG
s_mov_b64 exec, 1
buffer_store_byte v8, off, s[24:27], s46 sc1
s_mov_b64 exec, -1
W2SIG:
v_mov_b32 v176, 0
v_mov_b32 v177, 0
v_mov_b32 v178, 0
v_mov_b32 v179, 0
v_mov_b32 v180, 0
v_mov_b32 v181, 0
v_mov_b32 v182, 0
v_mov_b32 v183, 0
v_mov_b32 v184, 0
v_mov_b32 v185, 0
v_mov_b32 v186, 0
v_mov_b32 v187, 0
v_mov_b32 v188, 0
v_mov_b32 v189, 0
v_mov_b32 v190, 0
v_mov_b32 v191, 0
v_mov_b32 v192, 0
v_mov_b32 v193, 0
v_mov_b32 v194, 0
v_mov_b32 v195, 0
v_mov_b32 v196, 0
v_mov_b32 v197, 0
v_mov_b32 v198, 0
v_mov_b32 v199, 0
v_mov_b32 v200, 0
v_mov_b32 v201, 0
v_mov_b32 v202, 0
v_mov_b32 v203, 0
v_mov_b32 v204, 0
v_mov_b32 v205, 0
v_mov_b32 v206, 0
v_mov_b32 v207, 0
s_mov_b32 s38, 0
buffer_load_short_d16_hi v176, v6, s[12:15], s38 offen
buffer_load_short_d16_hi v180, v6, s[16:19], s38 offen
s_mov_b32 s38, 14400
buffer_load_short_d16_hi v177, v6, s[12:15], s38 offen
buffer_load_short_d16_hi v181, v6, s[16:19], s38 offen
s_mov_b32 s38, 28800
buffer_load_short_d16_hi v178, v6, s[12:15], s38 offen
buffer_load_short_d16_hi v182, v6, s[16:19], s38 offen
s_mov_b32 s38, 43200
buffer_load_short_d16_hi v179, v6, s[12:15], s38 offen
buffer_load_short_d16_hi v183, v6, s[16:19], s38 offen
s_mov_b32 s38, 230400
buffer_load_short_d16_hi v184, v6, s[12:15], s38 offen
buffer_load_short_d16_hi v188, v6, s[16:19], s38 offen
s_mov_b32 s38, 244800
buffer_load_short_d16_hi v185, v6, s[12:15], s38 offen
buffer_load_short_d16_hi v189, v6, s[16:19], s38 offen
s_mov_b32 s38, 259200
buffer_load_short_d16_hi v186, v6, s[12:15], s38 offen
buffer_load_short_d16_hi v190, v6, s[16:19], s38 offen
s_mov_b32 s38, 273600
buffer_load_short_d16_hi v187, v6, s[12:15], s38 offen
buffer_load_short_d16_hi v191, v6, s[16:19], s38 offen
s_mov_b32 s38, 460800
buffer_load_short_d16_hi v192, v6, s[12:15], s38 offen
buffer_load_short_d16_hi v196, v6, s[16:19], s38 offen
s_mov_b32 s38, 475200
buffer_load_short_d16_hi v193, v6, s[12:15], s38 offen
buffer_load_short_d16_hi v197, v6, s[16:19], s38 offen
s_mov_b32 s38, 489600
buffer_load_short_d16_hi v194, v6, s[12:15], s38 offen
buffer_load_short_d16_hi v198, v6, s[16:19], s38 offen
s_mov_b32 s38, 504000
buffer_load_short_d16_hi v195, v6, s[12:15], s38 offen
buffer_load_short_d16_hi v199, v6, s[16:19], s38 offen
s_mov_b32 s38, 691200
buffer_load_short_d16_hi v200, v6, s[12:15], s38 offen
buffer_load_short_d16_hi v204, v6, s[16:19], s38 offen
s_mov_b32 s38, 705600
buffer_load_short_d16_hi v201, v6, s[12:15], s38 offen
buffer_load_short_d16_hi v205, v6, s[16:19], s38 offen
s_mov_b32 s38, 720000
buffer_load_short_d16_hi v202, v6, s[12:15], s38 offen
buffer_load_short_d16_hi v206, v6, s[16:19], s38 offen
s_mov_b32 s38, 734400
buffer_load_short_d16_hi v203, v6, s[12:15], s38 offen
buffer_load_short_d16_hi v207, v6, s[16:19], s38 offen
K2W_137:
s_cmp_eq_u32 s56, 2
s_cbranch_scc1 K2W_138
s_waitcnt vmcnt(24)
v_mov_b32 v208, 0
v_mov_b32 v209, 0
v_mov_b32 v210, 0
v_mov_b32 v211, 0
v_mov_b32 v212, 0
v_mov_b32 v213, 0
v_mov_b32 v214, 0
v_mov_b32 v215, 0
v_mov_b32 v216, 0
v_mov_b32 v217, 0
v_mov_b32 v218, 0
v_mov_b32 v219, 0
v_mov_b32 v220, 0
v_mov_b32 v221, 0
v_mov_b32 v222, 0
v_mov_b32 v223, 0
v_mov_b32 v224, 0
v_mov_b32 v225, 0
v_mov_b32 v226, 0
v_mov_b32 v227, 0
v_mov_b32 v228, 0
v_mov_b32 v229, 0
v_mov_b32 v230, 0
v_mov_b32 v231, 0
v_mov_b32 v232, 0
v_mov_b32 v233, 0
v_mov_b32 v234, 0
v_mov_b32 v235, 0
v_mov_b32 v236, 0
v_mov_b32 v237, 0
v_mov_b32 v238, 0
v_mov_b32 v239, 0
s_mov_b32 s38, 0
buffer_load_short_d16_hi v208, v7, s[12:15], s38 offen
buffer_load_short_d16_hi v212, v7, s[16:19], s38 offen
s_mov_b32 s38, 14400
buffer_load_short_d16_hi v209, v7, s[12:15], s38 offen
buffer_load_short_d16_hi v213, v7, s[16:19], s38 offen
s_mov_b32 s38, 28800
buffer_load_short_d16_hi v210, v7, s[12:15], s38 offen
buffer_load_short_d16_hi v214, v7, s[16:19], s38 offen
s_mov_b32 s38, 43200
buffer_load_short_d16_hi v211, v7, s[12:15], s38 offen
buffer_load_short_d16_hi v215, v7, s[16:19], s38 offen
s_mov_b32 s38, 230400
buffer_load_short_d16_hi v216, v7, s[12:15], s38 offen
buffer_load_short_d16_hi v220, v7, s[16:19], s38 offen
s_mov_b32 s38, 244800
buffer_load_short_d16_hi v217, v7, s[12:15], s38 offen
buffer_load_short_d16_hi v221, v7, s[16:19], s38 offen
s_mov_b32 s38, 259200
buffer_load_short_d16_hi v218, v7, s[12:15], s38 offen
buffer_load_short_d16_hi v222, v7, s[16:19], s38 offen
s_mov_b32 s38, 273600
buffer_load_short_d16_hi v219, v7, s[12:15], s38 offen
buffer_load_short_d16_hi v223, v7, s[16:19], s38 offen
s_mov_b32 s38, 460800
buffer_load_short_d16_hi v224, v7, s[12:15], s38 offen
buffer_load_short_d16_hi v228, v7, s[16:19], s38 offen
s_mov_b32 s38, 475200
buffer_load_short_d16_hi v225, v7, s[12:15], s38 offen
buffer_load_short_d16_hi v229, v7, s[16:19], s38 offen
s_mov_b32 s38, 489600
buffer_load_short_d16_hi v226, v7, s[12:15], s38 offen
buffer_load_short_d16_hi v230, v7, s[16:19], s38 offen
s_mov_b32 s38, 504000
buffer_load_short_d16_hi v227, v7, s[12:15], s38 offen
buffer_load_short_d16_hi v231, v7, s[16:19], s38 offen
s_mov_b32 s38, 691200
buffer_load_short_d16_hi v232, v7, s[12:15], s38 offen
buffer_load_short_d16_hi v236, v7, s[16:19], s38 offen
s_mov_b32 s38, 705600
buffer_load_short_d16_hi v233, v7, s[12:15], s38 offen
buffer_load_short_d16_hi v237, v7, s[16:19], s38 offen
s_mov_b32 s38, 720000
buffer_load_short_d16_hi v234, v7, s[12:15], s38 offen
buffer_load_short_d16_hi v238, v7, s[16:19], s38 offen
s_mov_b32 s38, 734400
buffer_load_short_d16_hi v235, v7, s[12:15], s38 offen
buffer_load_short_d16_hi v239, v7, s[16:19], s38 offen
K2W_138:
v_cvt_f32_u32 v6, v2
v_mul_f32 v6, 0x3c800000, v6
v_lshlrev_b32 v7, 2, v3
v_cvt_f32_u32 v7, v7
v_mul_f32 v7, v7, v6
s_mov_b32 s40, 0x8000
s_mov_b32 s41, 0x80000000
v_fmamk_f32 v8, v6, 0x00000000, v7
v_fmamk_f32 v9, v6, 0x3f800000, v7
v_fmamk_f32 v10, v6, 0x40000000, v7
v_fmamk_f32 v11, v6, 0x40400000, v7
v_sin_f32 v12, v8
v_sin_f32 v13, v9
v_sin_f32 v14, v10
v_sin_f32 v15, v11
v_cos_f32 v8, v8
v_cos_f32 v9, v9
v_cos_f32 v10, v10
v_cos_f32 v11, v11
s_nop 0
v_cvt_pk_bf16_f32 v32, v8, v12
v_cvt_pk_bf16_f32 v36, -v12, v8
v_cvt_pk_bf16_f32 v40, v9, v13
v_cvt_pk_bf16_f32 v44, -v13, v9
v_cvt_pk_bf16_f32 v48, v10, v14
v_cvt_pk_bf16_f32 v52, -v14, v10
v_cvt_pk_bf16_f32 v56, v11, v15
v_cvt_pk_bf16_f32 v60, -v15, v11
v_fmamk_f32 v8, v6, 0x41800000, v7
v_fmamk_f32 v9, v6, 0x41880000, v7
v_fmamk_f32 v10, v6, 0x41900000, v7
v_fmamk_f32 v11, v6, 0x41980000, v7
v_sin_f32 v12, v8
v_sin_f32 v13, v9
v_sin_f32 v14, v10
v_sin_f32 v15, v11
v_cos_f32 v8, v8
v_cos_f32 v9, v9
v_cos_f32 v10, v10
v_cos_f32 v11, v11
s_nop 0
v_cvt_pk_bf16_f32 v33, v8, v12
v_cvt_pk_bf16_f32 v37, -v12, v8
v_cvt_pk_bf16_f32 v41, v9, v13
v_cvt_pk_bf16_f32 v45, -v13, v9
v_cvt_pk_bf16_f32 v49, v10, v14
v_cvt_pk_bf16_f32 v53, -v14, v10
v_cvt_pk_bf16_f32 v57, v11, v15
v_cvt_pk_bf16_f32 v61, -v15, v11
v_fmamk_f32 v8, v6, 0x42000000, v7
v_fmamk_f32 v9, v6, 0x42040000, v7
v_fmamk_f32 v10, v6, 0x42080000, v7
v_fmamk_f32 v11, v6, 0x420c0000, v7
v_sin_f32 v12, v8
v_sin_f32 v13, v9
v_sin_f32 v14, v10
v_sin_f32 v15, v11
v_cos_f32 v8, v8
v_cos_f32 v9, v9
v_cos_f32 v10, v10
v_cos_f32 v11, v11
s_nop 0
v_cvt_pk_bf16_f32 v34, v8, v12
v_cvt_pk_bf16_f32 v38, -v12, v8
v_cvt_pk_bf16_f32 v42, v9, v13
v_cvt_pk_bf16_f32 v46, -v13, v9
v_cvt_pk_bf16_f32 v50, v10, v14
v_cvt_pk_bf16_f32 v54, -v14, v10
v_cvt_pk_bf16_f32 v58, v11, v15
v_cvt_pk_bf16_f32 v62, -v15, v11
v_fmamk_f32 v8, v6, 0x42400000, v7
v_fmamk_f32 v9, v6, 0x42440000, v7
v_fmamk_f32 v10, v6, 0x42480000, v7
v_fmamk_f32 v11, v6, 0x424c0000, v7
v_sin_f32 v12, v8
v_sin_f32 v13, v9
v_sin_f32 v14, v10
v_sin_f32 v15, v11
v_cos_f32 v8, v8
v_cos_f32 v9, v9
v_cos_f32 v10, v10
v_cos_f32 v11, v11
s_nop 0
v_cvt_pk_bf16_f32 v35, v8, v12
v_cvt_pk_bf16_f32 v39, -v12, v8
v_cvt_pk_bf16_f32 v43, v9, v13
v_cvt_pk_bf16_f32 v47, -v13, v9
v_cvt_pk_bf16_f32 v51, v10, v14
v_cvt_pk_bf16_f32 v55, -v14, v10
v_cvt_pk_bf16_f32 v59, v11, v15
v_cvt_pk_bf16_f32 v63, -v15, v11
s_lshl_b32 s38, s49, 2
v_add_u32 v8, s38, v3
v_cmp_gt_u32 vcc, 14, v8
v_lshlrev_b32 v9, 4, v2
s_nop 0
v_cndmask_b32 v8, 0, v8, vcc
v_add_u32 v8, v8, v9
v_lshlrev_b32 v8, 8, v8
v_add_u32 v26, 13631488, v8
v_lshlrev_b32 v6, 10, v3
v_lshl_add_u32 v6, v2, 4, v6
s_lshl_b32 s38, s49, 2
s_lshr_b32 s39, s32, 2
s_lshl_b32 s39, s39, 14
s_add_u32 s38, s38, s39
v_add_u32 v6, s38, v6
s_lshl_b32 s38, s32, 12
v_add_u32 v1, s38, v4
v_lshlrev_b32 v28, 2, v0
s_mov_b32 s58, 1
K2REAL:
s_cmp_gt_u32 s32, 3
s_cbranch_scc1 K2NP_139
v_and_b32 v10, 3, v0
v_cmp_eq_u32 vcc, 3, v10
v_mov_b32 v10, 0x1010000
s_nop 0
v_cndmask_b32 v11, 0, v10, vcc
buffer_load_dword v9, v28, s[24:27], 0 offen sc1
s_waitcnt vmcnt(0)
PL_140:
v_and_b32 v10, v9, v11
v_cmp_ne_u32 vcc, v10, v11
s_nop 1
s_cbranch_vccz POK_141
s_sub_u32 s59, s59, 1
s_cbranch_scc1 POK_141
s_sleep 2
buffer_load_dword v9, v28, s[24:27], 0 offen sc1
s_waitcnt vmcnt(0)
s_branch PL_140
POK_141:
buffer_load_dword v9, v26, s[20:23], 0 offen sc1
s_waitcnt vmcnt(0)
PL_142:
v_cmp_ne_u32 vcc, 1, v9
s_nop 1
s_cbranch_vccz POK_143
s_sub_u32 s59, s59, 1
s_cbranch_scc1 POK_143
s_sleep 2
buffer_load_dword v9, v26, s[20:23], 0 offen sc1
s_waitcnt vmcnt(0)
s_branch PL_142
POK_143:
K2NP_139:
s_barrier
buffer_load_dwordx4 v[96:99], v4, s[20:23], s52 offen offset:0 sc1
buffer_load_dwordx4 v[100:103], v4, s[20:23], s52 offen offset:1024 sc1
buffer_load_dwordx4 v[104:107], v4, s[20:23], s52 offen offset:2048 sc1
buffer_load_dwordx4 v[108:111], v4, s[20:23], s52 offen offset:3072 sc1
s_cmp_eq_u32 s56, 2
s_cbranch_scc1 K2X_144
buffer_load_dwordx4 v[112:115], v4, s[20:23], s53 offen offset:0 sc1
buffer_load_dwordx4 v[116:119], v4, s[20:23], s53 offen offset:1024 sc1
buffer_load_dwordx4 v[120:123], v4, s[20:23], s53 offen offset:2048 sc1
buffer_load_dwordx4 v[124:127], v4, s[20:23], s53 offen offset:3072 sc1
K2X_144:
s_waitcnt vmcnt(0)
CK_145:
v_max_u32 v8, v96, v100
v_max3_u32 v8, v8, v104, v108
v_max3_u32 v8, v8, v112, v116
v_max3_u32 v8, v8, v120, v124
v_cmp_eq_u32 vcc, -1, v8
s_nop 1
s_cbranch_vccz CKOK_146
s_sub_u32 s59, s59, 1
s_cbranch_scc1 CKOK_146
s_sleep 2
buffer_load_dwordx4 v[96:99], v4, s[20:23], s52 offen offset:0 sc1
buffer_load_dwordx4 v[100:103], v4, s[20:23], s52 offen offset:1024 sc1
buffer_load_dwordx4 v[104:107], v4, s[20:23], s52 offen offset:2048 sc1
buffer_load_dwordx4 v[108:111], v4, s[20:23], s52 offen offset:3072 sc1
s_cmp_eq_u32 s56, 2
s_cbranch_scc1 K2X_147
buffer_load_dwordx4 v[112:115], v4, s[20:23], s53 offen offset:0 sc1
buffer_load_dwordx4 v[116:119], v4, s[20:23], s53 offen offset:1024 sc1
buffer_load_dwordx4 v[120:123], v4, s[20:23], s53 offen offset:2048 sc1
buffer_load_dwordx4 v[124:127], v4, s[20:23], s53 offen offset:3072 sc1
K2X_147:
s_waitcnt vmcnt(0)
s_branch CK_145
CKOK_146:
K2GO:
v_mov_b32 v128, v96
v_mov_b32 v129, v100
v_mov_b32 v130, v104
v_mov_b32 v131, v108
v_mov_b32 v132, v97
v_mov_b32 v133, v101
v_mov_b32 v134, v105
v_mov_b32 v135, v109
v_mov_b32 v136, v98
v_mov_b32 v137, v102
v_mov_b32 v138, v106
v_mov_b32 v139, v110
v_mov_b32 v140, v99
v_mov_b32 v141, v103
v_mov_b32 v142, v107
v_mov_b32 v143, v111
s_nop 1
v_mfma_f32_16x16x32_bf16 v[64:67], v[32:35], v[128:131], 0
v_mfma_f32_16x16x32_bf16 v[68:71], v[36:39], v[128:131], 0
v_mfma_f32_16x16x32_bf16 v[80:83], v[48:51], v[136:139], 0
v_mfma_f32_16x16x32_bf16 v[84:87], v[52:55], v[136:139], 0
v_mfma_f32_16x16x32_bf16 v[72:75], v[40:43], v[132:135], 0
v_mfma_f32_16x16x32_bf16 v[76:79], v[44:47], v[132:135], 0
v_mfma_f32_16x16x32_bf16 v[88:91], v[56:59], v[140:143], 0
v_mfma_f32_16x16x32_bf16 v[92:95], v[60:63], v[140:143], 0
s_nop 3
v_pk_add_f32 v[8:9], v[64:65], v[80:81]
v_pk_add_f32 v[16:17], v[64:65], v[80:81] neg_lo:[0,1] neg_hi:[0,1]
v_pk_add_f32 v[10:11], v[66:67], v[82:83]
v_pk_add_f32 v[18:19], v[66:67], v[82:83] neg_lo:[0,1] neg_hi:[0,1]
v_pk_add_f32 v[12:13], v[68:69], v[84:85]
v_pk_add_f32 v[20:21], v[68:69], v[84:85] neg_lo:[0,1] neg_hi:[0,1]
v_pk_add_f32 v[14:15], v[70:71], v[86:87]
v_pk_add_f32 v[22:23], v[70:71], v[86:87] neg_lo:[0,1] neg_hi:[0,1]
v_pk_add_f32 v[64:65], v[72:73], v[88:89]
v_pk_add_f32 v[80:81], v[72:73], v[88:89] neg_lo:[0,1] neg_hi:[0,1]
v_pk_add_f32 v[66:67], v[74:75], v[90:91]
v_pk_add_f32 v[82:83], v[74:75], v[90:91] neg_lo:[0,1] neg_hi:[0,1]
v_pk_add_f32 v[68:69], v[76:77], v[92:93]
v_pk_add_f32 v[84:85], v[76:77], v[92:93] neg_lo:[0,1] neg_hi:[0,1]
v_pk_add_f32 v[70:71], v[78:79], v[94:95]
v_pk_add_f32 v[86:87], v[78:79], v[94:95] neg_lo:[0,1] neg_hi:[0,1]
v_pk_add_f32 v[144:145], v[8:9], v[64:65]
v_pk_add_f32 v[160:161], v[8:9], v[64:65] neg_lo:[0,1] neg_hi:[0,1]
v_pk_add_f32 v[146:147], v[10:11], v[66:67]
v_pk_add_f32 v[162:163], v[10:11], v[66:67] neg_lo:[0,1] neg_hi:[0,1]
v_pk_add_f32 v[148:149], v[12:13], v[68:69]
v_pk_add_f32 v[164:165], v[12:13], v[68:69] neg_lo:[0,1] neg_hi:[0,1]
v_pk_add_f32 v[150:151], v[14:15], v[70:71]
v_pk_add_f32 v[166:167], v[14:15], v[70:71] neg_lo:[0,1] neg_hi:[0,1]
v_pk_add_f32 v[152:153], v[16:17], v[84:85]
v_pk_add_f32 v[156:157], v[20:21], v[80:81] neg_lo:[0,1] neg_hi:[0,1]
v_pk_add_f32 v[168:169], v[16:17], v[84:85] neg_lo:[0,1] neg_hi:[0,1]
v_pk_add_f32 v[172:173], v[20:21], v[80:81]
v_pk_add_f32 v[154:155], v[18:19], v[86:87]
v_pk_add_f32 v[158:159], v[22:23], v[82:83] neg_lo:[0,1] neg_hi:[0,1]
v_pk_add_f32 v[170:171], v[18:19], v[86:87] neg_lo:[0,1] neg_hi:[0,1]
v_pk_add_f32 v[174:175], v[22:23], v[82:83]
v_pk_mul_f32 v[8:9], v[144:145], v[176:177]
v_pk_mul_f32 v[12:13], v[144:145], v[180:181]
v_pk_mul_f32 v[10:11], v[146:147], v[178:179]
v_pk_mul_f32 v[14:15], v[146:147], v[182:183]
v_pk_fma_f32 v[8:9], v[148:149], v[180:181], v[8:9] neg_lo:[1,0,0] neg_hi:[1,0,0]
v_pk_fma_f32 v[12:13], v[148:149], v[176:177], v[12:13]
v_pk_fma_f32 v[10:11], v[150:151], v[182:183], v[10:11] neg_lo:[1,0,0] neg_hi:[1,0,0]
v_pk_fma_f32 v[14:15], v[150:151], v[178:179], v[14:15]
v_cvt_pk_bf16_f32 v128, v8, -v12
v_cvt_pk_bf16_f32 v132, v9, -v13
v_cvt_pk_bf16_f32 v136, v10, -v14
v_cvt_pk_bf16_f32 v140, v11, -v15
v_pk_mul_f32 v[16:17], v[152:153], v[184:185]
v_pk_mul_f32 v[20:21], v[152:153], v[188:189]
v_pk_mul_f32 v[18:19], v[154:155], v[186:187]
v_pk_mul_f32 v[22:23], v[154:155], v[190:191]
v_pk_fma_f32 v[16:17], v[156:157], v[188:189], v[16:17] neg_lo:[1,0,0] neg_hi:[1,0,0]
v_pk_fma_f32 v[20:21], v[156:157], v[184:185], v[20:21]
v_pk_fma_f32 v[18:19], v[158:159], v[190:191], v[18:19] neg_lo:[1,0,0] neg_hi:[1,0,0]
v_pk_fma_f32 v[22:23], v[158:159], v[186:187], v[22:23]
v_cvt_pk_bf16_f32 v129, v16, -v20
v_cvt_pk_bf16_f32 v133, v17, -v21
v_cvt_pk_bf16_f32 v137, v18, -v22
v_cvt_pk_bf16_f32 v141, v19, -v23
v_pk_mul_f32 v[8:9], v[160:161], v[192:193]
v_pk_mul_f32 v[12:13], v[160:161], v[196:197]
v_pk_mul_f32 v[10:11], v[162:163], v[194:195]
v_pk_mul_f32 v[14:15], v[162:163], v[198:199]
v_pk_fma_f32 v[8:9], v[164:165], v[196:197], v[8:9] neg_lo:[1,0,0] neg_hi:[1,0,0]
v_pk_fma_f32 v[12:13], v[164:165], v[192:193], v[12:13]
v_pk_fma_f32 v[10:11], v[166:167], v[198:199], v[10:11] neg_lo:[1,0,0] neg_hi:[1,0,0]
v_pk_fma_f32 v[14:15], v[166:167], v[194:195], v[14:15]
v_cvt_pk_bf16_f32 v130, v8, -v12
v_cvt_pk_bf16_f32 v134, v9, -v13
v_cvt_pk_bf16_f32 v138, v10, -v14
v_cvt_pk_bf16_f32 v142, v11, -v15
v_pk_mul_f32 v[16:17], v[168:169], v[200:201]
v_pk_mul_f32 v[20:21], v[168:169], v[204:205]
v_pk_mul_f32 v[18:19], v[170:171], v[202:203]
v_pk_mul_f32 v[22:23], v[170:171], v[206:207]
v_pk_fma_f32 v[16:17], v[172:173], v[204:205], v[16:17] neg_lo:[1,0,0] neg_hi:[1,0,0]
v_pk_fma_f32 v[20:21], v[172:173], v[200:201], v[20:21]
v_pk_fma_f32 v[18:19], v[174:175], v[206:207], v[18:19] neg_lo:[1,0,0] neg_hi:[1,0,0]
v_pk_fma_f32 v[22:23], v[174:175], v[202:203], v[22:23]
v_cvt_pk_bf16_f32 v131, v16, -v20
v_cvt_pk_bf16_f32 v135, v17, -v21
v_cvt_pk_bf16_f32 v139, v18, -v22
v_cvt_pk_bf16_f32 v143, v19, -v23
s_nop 1
v_mfma_f32_16x16x32_bf16 v[64:67], v[32:35], v[128:131], 0
v_mfma_f32_16x16x32_bf16 v[68:71], v[36:39], v[128:131], 0
v_mfma_f32_16x16x32_bf16 v[80:83], v[48:51], v[136:139], 0
v_mfma_f32_16x16x32_bf16 v[84:87], v[52:55], v[136:139], 0
v_mfma_f32_16x16x32_bf16 v[72:75], v[40:43], v[132:135], 0
v_mfma_f32_16x16x32_bf16 v[76:79], v[44:47], v[132:135], 0
v_mfma_f32_16x16x32_bf16 v[88:91], v[56:59], v[140:143], 0
v_mfma_f32_16x16x32_bf16 v[92:95], v[60:63], v[140:143], 0
s_nop 3
v_pk_add_f32 v[8:9], v[64:65], v[80:81]
v_pk_add_f32 v[16:17], v[64:65], v[80:81] neg_lo:[0,1] neg_hi:[0,1]
v_pk_add_f32 v[10:11], v[66:67], v[82:83]
v_pk_add_f32 v[18:19], v[66:67], v[82:83] neg_lo:[0,1] neg_hi:[0,1]
v_pk_add_f32 v[12:13], v[68:69], v[84:85]
v_pk_add_f32 v[20:21], v[68:69], v[84:85] neg_lo:[0,1] neg_hi:[0,1]
v_pk_add_f32 v[14:15], v[70:71], v[86:87]
v_pk_add_f32 v[22:23], v[70:71], v[86:87] neg_lo:[0,1] neg_hi:[0,1]
v_pk_add_f32 v[64:65], v[72:73], v[88:89]
v_pk_add_f32 v[80:81], v[72:73], v[88:89] neg_lo:[0,1] neg_hi:[0,1]
v_pk_add_f32 v[66:67], v[74:75], v[90:91]
v_pk_add_f32 v[82:83], v[74:75], v[90:91] neg_lo:[0,1] neg_hi:[0,1]
v_pk_add_f32 v[68:69], v[76:77], v[92:93]
v_pk_add_f32 v[84:85], v[76:77], v[92:93] neg_lo:[0,1] neg_hi:[0,1]
v_pk_add_f32 v[70:71], v[78:79], v[94:95]
v_pk_add_f32 v[86:87], v[78:79], v[94:95] neg_lo:[0,1] neg_hi:[0,1]
v_pk_add_f32 v[144:145], v[8:9], v[64:65]
v_pk_add_f32 v[160:161], v[8:9], v[64:65] neg_lo:[0,1] neg_hi:[0,1]
v_pk_add_f32 v[146:147], v[10:11], v[66:67]
v_pk_add_f32 v[162:163], v[10:11], v[66:67] neg_lo:[0,1] neg_hi:[0,1]
v_pk_add_f32 v[148:149], v[12:13], v[68:69]
v_pk_add_f32 v[164:165], v[12:13], v[68:69] neg_lo:[0,1] neg_hi:[0,1]
v_pk_add_f32 v[150:151], v[14:15], v[70:71]
v_pk_add_f32 v[166:167], v[14:15], v[70:71] neg_lo:[0,1] neg_hi:[0,1]
v_pk_add_f32 v[152:153], v[16:17], v[84:85]
v_pk_add_f32 v[156:157], v[20:21], v[80:81] neg_lo:[0,1] neg_hi:[0,1]
v_pk_add_f32 v[168:169], v[16:17], v[84:85] neg_lo:[0,1] neg_hi:[0,1]
v_pk_add_f32 v[172:173], v[20:21], v[80:81]
v_pk_add_f32 v[154:155], v[18:19], v[86:87]
v_pk_add_f32 v[158:159], v[22:23], v[82:83] neg_lo:[0,1] neg_hi:[0,1]
v_pk_add_f32 v[170:171], v[18:19], v[86:87] neg_lo:[0,1] neg_hi:[0,1]
v_pk_add_f32 v[174:175], v[22:23], v[82:83]
v_cvt_pk_bf16_f32 v8, v144, -v148
ds_write_b32 v6, v8 offset:0
v_cvt_pk_bf16_f32 v9, v145, -v149
ds_write_b32 v6, v9 offset:256
v_cvt_pk_bf16_f32 v10, v146, -v150
ds_write_b32 v6, v10 offset:512
v_cvt_pk_bf16_f32 v11, v147, -v151
ds_write_b32 v6, v11 offset:768
v_cvt_pk_bf16_f32 v8, v152, -v156
ds_write_b32 v6, v8 offset:4096
v_cvt_pk_bf16_f32 v9, v153, -v157
ds_write_b32 v6, v9 offset:4352
v_cvt_pk_bf16_f32 v10, v154, -v158
ds_write_b32 v6, v10 offset:4608
v_cvt_pk_bf16_f32 v11, v155, -v159
ds_write_b32 v6, v11 offset:4864
v_cvt_pk_bf16_f32 v8, v160, -v164
ds_write_b32 v6, v8 offset:8192
v_cvt_pk_bf16_f32 v9, v161, -v165
ds_write_b32 v6, v9 offset:8448
v_cvt_pk_bf16_f32 v10, v162, -v166
ds_write_b32 v6, v10 offset:8704
v_cvt_pk_bf16_f32 v11, v163, -v167
ds_write_b32 v6, v11 offset:8960
v_cvt_pk_bf16_f32 v8, v168, -v172
ds_write_b32 v6, v8 offset:12288
v_cvt_pk_bf16_f32 v9, v169, -v173
ds_write_b32 v6, v9 offset:12544
v_cvt_pk_bf16_f32 v10, v170, -v174
ds_write_b32 v6, v10 offset:12800
v_cvt_pk_bf16_f32 v11, v171, -v175
ds_write_b32 v6, v11 offset:13056
s_cmp_eq_u32 s56, 2
s_cbranch_scc1 K2BAR_148
v_mov_b32 v128, v112
v_mov_b32 v129, v116
v_mov_b32 v130, v120
v_mov_b32 v131, v124
v_mov_b32 v132, v113
v_mov_b32 v133, v117
v_mov_b32 v134, v121
v_mov_b32 v135, v125
v_mov_b32 v136, v114
v_mov_b32 v137, v118
v_mov_b32 v138, v122
v_mov_b32 v139, v126
v_mov_b32 v140, v115
v_mov_b32 v141, v119
v_mov_b32 v142, v123
v_mov_b32 v143, v127
s_nop 1
v_mfma_f32_16x16x32_bf16 v[64:67], v[32:35], v[128:131], 0
v_mfma_f32_16x16x32_bf16 v[68:71], v[36:39], v[128:131], 0
v_mfma_f32_16x16x32_bf16 v[80:83], v[48:51], v[136:139], 0
v_mfma_f32_16x16x32_bf16 v[84:87], v[52:55], v[136:139], 0
v_mfma_f32_16x16x32_bf16 v[72:75], v[40:43], v[132:135], 0
v_mfma_f32_16x16x32_bf16 v[76:79], v[44:47], v[132:135], 0
v_mfma_f32_16x16x32_bf16 v[88:91], v[56:59], v[140:143], 0
v_mfma_f32_16x16x32_bf16 v[92:95], v[60:63], v[140:143], 0
s_nop 3
v_pk_add_f32 v[8:9], v[64:65], v[80:81]
v_pk_add_f32 v[16:17], v[64:65], v[80:81] neg_lo:[0,1] neg_hi:[0,1]
v_pk_add_f32 v[10:11], v[66:67], v[82:83]
v_pk_add_f32 v[18:19], v[66:67], v[82:83] neg_lo:[0,1] neg_hi:[0,1]
v_pk_add_f32 v[12:13], v[68:69], v[84:85]
v_pk_add_f32 v[20:21], v[68:69], v[84:85] neg_lo:[0,1] neg_hi:[0,1]
v_pk_add_f32 v[14:15], v[70:71], v[86:87]
v_pk_add_f32 v[22:23], v[70:71], v[86:87] neg_lo:[0,1] neg_hi:[0,1]
v_pk_add_f32 v[64:65], v[72:73], v[88:89]
v_pk_add_f32 v[80:81], v[72:73], v[88:89] neg_lo:[0,1] neg_hi:[0,1]
v_pk_add_f32 v[66:67], v[74:75], v[90:91]
v_pk_add_f32 v[82:83], v[74:75], v[90:91] neg_lo:[0,1] neg_hi:[0,1]
v_pk_add_f32 v[68:69], v[76:77], v[92:93]
v_pk_add_f32 v[84:85], v[76:77], v[92:93] neg_lo:[0,1] neg_hi:[0,1]
v_pk_add_f32 v[70:71], v[78:79], v[94:95]
v_pk_add_f32 v[86:87], v[78:79], v[94:95] neg_lo:[0,1] neg_hi:[0,1]
v_pk_add_f32 v[144:145], v[8:9], v[64:65]
v_pk_add_f32 v[160:161], v[8:9], v[64:65] neg_lo:[0,1] neg_hi:[0,1]
v_pk_add_f32 v[146:147], v[10:11], v[66:67]
v_pk_add_f32 v[162:163], v[10:11], v[66:67] neg_lo:[0,1] neg_hi:[0,1]
v_pk_add_f32 v[148:149], v[12:13], v[68:69]
v_pk_add_f32 v[164:165], v[12:13], v[68:69] neg_lo:[0,1] neg_hi:[0,1]
v_pk_add_f32 v[150:151], v[14:15], v[70:71]
v_pk_add_f32 v[166:167], v[14:15], v[70:71] neg_lo:[0,1] neg_hi:[0,1]
v_pk_add_f32 v[152:153], v[16:17], v[84:85]
v_pk_add_f32 v[156:157], v[20:21], v[80:81] neg_lo:[0,1] neg_hi:[0,1]
v_pk_add_f32 v[168:169], v[16:17], v[84:85] neg_lo:[0,1] neg_hi:[0,1]
v_pk_add_f32 v[172:173], v[20:21], v[80:81]
v_pk_add_f32 v[154:155], v[18:19], v[86:87]
v_pk_add_f32 v[158:159], v[22:23], v[82:83] neg_lo:[0,1] neg_hi:[0,1]
v_pk_add_f32 v[170:171], v[18:19], v[86:87] neg_lo:[0,1] neg_hi:[0,1]
v_pk_add_f32 v[174:175], v[22:23], v[82:83]
v_pk_mul_f32 v[8:9], v[144:145], v[208:209]
v_pk_mul_f32 v[12:13], v[144:145], v[212:213]
v_pk_mul_f32 v[10:11], v[146:147], v[210:211]
v_pk_mul_f32 v[14:15], v[146:147], v[214:215]
v_pk_fma_f32 v[8:9], v[148:149], v[212:213], v[8:9] neg_lo:[1,0,0] neg_hi:[1,0,0]
v_pk_fma_f32 v[12:13], v[148:149], v[208:209], v[12:13]
v_pk_fma_f32 v[10:11], v[150:151], v[214:215], v[10:11] neg_lo:[1,0,0] neg_hi:[1,0,0]
v_pk_fma_f32 v[14:15], v[150:151], v[210:211], v[14:15]
v_cvt_pk_bf16_f32 v128, v8, -v12
v_cvt_pk_bf16_f32 v132, v9, -v13
v_cvt_pk_bf16_f32 v136, v10, -v14
v_cvt_pk_bf16_f32 v140, v11, -v15
v_pk_mul_f32 v[16:17], v[152:153], v[216:217]
v_pk_mul_f32 v[20:21], v[152:153], v[220:221]
v_pk_mul_f32 v[18:19], v[154:155], v[218:219]
v_pk_mul_f32 v[22:23], v[154:155], v[222:223]
v_pk_fma_f32 v[16:17], v[156:157], v[220:221], v[16:17] neg_lo:[1,0,0] neg_hi:[1,0,0]
v_pk_fma_f32 v[20:21], v[156:157], v[216:217], v[20:21]
v_pk_fma_f32 v[18:19], v[158:159], v[222:223], v[18:19] neg_lo:[1,0,0] neg_hi:[1,0,0]
v_pk_fma_f32 v[22:23], v[158:159], v[218:219], v[22:23]
v_cvt_pk_bf16_f32 v129, v16, -v20
v_cvt_pk_bf16_f32 v133, v17, -v21
v_cvt_pk_bf16_f32 v137, v18, -v22
v_cvt_pk_bf16_f32 v141, v19, -v23
v_pk_mul_f32 v[8:9], v[160:161], v[224:225]
v_pk_mul_f32 v[12:13], v[160:161], v[228:229]
v_pk_mul_f32 v[10:11], v[162:163], v[226:227]
v_pk_mul_f32 v[14:15], v[162:163], v[230:231]
v_pk_fma_f32 v[8:9], v[164:165], v[228:229], v[8:9] neg_lo:[1,0,0] neg_hi:[1,0,0]
v_pk_fma_f32 v[12:13], v[164:165], v[224:225], v[12:13]
v_pk_fma_f32 v[10:11], v[166:167], v[230:231], v[10:11] neg_lo:[1,0,0] neg_hi:[1,0,0]
v_pk_fma_f32 v[14:15], v[166:167], v[226:227], v[14:15]
v_cvt_pk_bf16_f32 v130, v8, -v12
v_cvt_pk_bf16_f32 v134, v9, -v13
v_cvt_pk_bf16_f32 v138, v10, -v14
v_cvt_pk_bf16_f32 v142, v11, -v15
v_pk_mul_f32 v[16:17], v[168:169], v[232:233]
v_pk_mul_f32 v[20:21], v[168:169], v[236:237]
v_pk_mul_f32 v[18:19], v[170:171], v[234:235]
v_pk_mul_f32 v[22:23], v[170:171], v[238:239]
v_pk_fma_f32 v[16:17], v[172:173], v[236:237], v[16:17] neg_lo:[1,0,0] neg_hi:[1,0,0]
v_pk_fma_f32 v[20:21], v[172:173], v[232:233], v[20:21]
v_pk_fma_f32 v[18:19], v[174:175], v[238:239], v[18:19] neg_lo:[1,0,0] neg_hi:[1,0,0]
v_pk_fma_f32 v[22:23], v[174:175], v[234:235], v[22:23]
v_cvt_pk_bf16_f32 v131, v16, -v20
v_cvt_pk_bf16_f32 v135, v17, -v21
v_cvt_pk_bf16_f32 v139, v18, -v22
v_cvt_pk_bf16_f32 v143, v19, -v23
s_nop 1
v_mfma_f32_16x16x32_bf16 v[64:67], v[32:35], v[128:131], 0
v_mfma_f32_16x16x32_bf16 v[68:71], v[36:39], v[128:131], 0
v_mfma_f32_16x16x32_bf16 v[80:83], v[48:51], v[136:139], 0
v_mfma_f32_16x16x32_bf16 v[84:87], v[52:55], v[136:139], 0
v_mfma_f32_16x16x32_bf16 v[72:75], v[40:43], v[132:135], 0
v_mfma_f32_16x16x32_bf16 v[76:79], v[44:47], v[132:135], 0
v_mfma_f32_16x16x32_bf16 v[88:91], v[56:59], v[140:143], 0
v_mfma_f32_16x16x32_bf16 v[92:95], v[60:63], v[140:143], 0
s_nop 3
v_pk_add_f32 v[8:9], v[64:65], v[80:81]
v_pk_add_f32 v[16:17], v[64:65], v[80:81] neg_lo:[0,1] neg_hi:[0,1]
v_pk_add_f32 v[10:11], v[66:67], v[82:83]
v_pk_add_f32 v[18:19], v[66:67], v[82:83] neg_lo:[0,1] neg_hi:[0,1]
v_pk_add_f32 v[12:13], v[68:69], v[84:85]
v_pk_add_f32 v[20:21], v[68:69], v[84:85] neg_lo:[0,1] neg_hi:[0,1]
v_pk_add_f32 v[14:15], v[70:71], v[86:87]
v_pk_add_f32 v[22:23], v[70:71], v[86:87] neg_lo:[0,1] neg_hi:[0,1]
v_pk_add_f32 v[64:65], v[72:73], v[88:89]
v_pk_add_f32 v[80:81], v[72:73], v[88:89] neg_lo:[0,1] neg_hi:[0,1]
v_pk_add_f32 v[66:67], v[74:75], v[90:91]
v_pk_add_f32 v[82:83], v[74:75], v[90:91] neg_lo:[0,1] neg_hi:[0,1]
v_pk_add_f32 v[68:69], v[76:77], v[92:93]
v_pk_add_f32 v[84:85], v[76:77], v[92:93] neg_lo:[0,1] neg_hi:[0,1]
v_pk_add_f32 v[70:71], v[78:79], v[94:95]
v_pk_add_f32 v[86:87], v[78:79], v[94:95] neg_lo:[0,1] neg_hi:[0,1]
v_pk_add_f32 v[144:145], v[8:9], v[64:65]
v_pk_add_f32 v[160:161], v[8:9], v[64:65] neg_lo:[0,1] neg_hi:[0,1]
v_pk_add_f32 v[146:147], v[10:11], v[66:67]
v_pk_add_f32 v[162:163], v[10:11], v[66:67] neg_lo:[0,1] neg_hi:[0,1]
v_pk_add_f32 v[148:149], v[12:13], v[68:69]
v_pk_add_f32 v[164:165], v[12:13], v[68:69] neg_lo:[0,1] neg_hi:[0,1]
v_pk_add_f32 v[150:151], v[14:15], v[70:71]
v_pk_add_f32 v[166:167], v[14:15], v[70:71] neg_lo:[0,1] neg_hi:[0,1]
v_pk_add_f32 v[152:153], v[16:17], v[84:85]
v_pk_add_f32 v[156:157], v[20:21], v[80:81] neg_lo:[0,1] neg_hi:[0,1]
v_pk_add_f32 v[168:169], v[16:17], v[84:85] neg_lo:[0,1] neg_hi:[0,1]
v_pk_add_f32 v[172:173], v[20:21], v[80:81]
v_pk_add_f32 v[154:155], v[18:19], v[86:87]
v_pk_add_f32 v[158:159], v[22:23], v[82:83] neg_lo:[0,1] neg_hi:[0,1]
v_pk_add_f32 v[170:171], v[18:19], v[86:87] neg_lo:[0,1] neg_hi:[0,1]
v_pk_add_f32 v[174:175], v[22:23], v[82:83]
s_cmp_eq_u32 s56, 1
s_cbranch_scc1 K2SP_149
v_cvt_pk_bf16_f32 v8, v144, -v148
ds_write_b32 v6, v8 offset:32768
v_cvt_pk_bf16_f32 v9, v145, -v149
ds_write_b32 v6, v9 offset:33024
v_cvt_pk_bf16_f32 v10, v146, -v150
ds_write_b32 v6, v10 offset:33280
v_cvt_pk_bf16_f32 v11, v147, -v151
ds_write_b32 v6, v11 offset:33536
v_cvt_pk_bf16_f32 v8, v152, -v156
ds_write_b32 v6, v8 offset:36864
v_cvt_pk_bf16_f32 v9, v153, -v157
ds_write_b32 v6, v9 offset:37120
v_cvt_pk_bf16_f32 v10, v154, -v158
ds_write_b32 v6, v10 offset:37376
v_cvt_pk_bf16_f32 v11, v155, -v159
ds_write_b32 v6, v11 offset:37632
v_cvt_pk_bf16_f32 v8, v160, -v164
ds_write_b32 v6, v8 offset:40960
v_cvt_pk_bf16_f32 v9, v161, -v165
ds_write_b32 v6, v9 offset:41216
v_cvt_pk_bf16_f32 v10, v162, -v166
ds_write_b32 v6, v10 offset:41472
v_cvt_pk_bf16_f32 v11, v163, -v167
ds_write_b32 v6, v11 offset:41728
v_cvt_pk_bf16_f32 v8, v168, -v172
ds_write_b32 v6, v8 offset:45056
v_cvt_pk_bf16_f32 v9, v169, -v173
ds_write_b32 v6, v9 offset:45312
v_cvt_pk_bf16_f32 v10, v170, -v174
ds_write_b32 v6, v10 offset:45568
v_cvt_pk_bf16_f32 v11, v171, -v175
ds_write_b32 v6, v11 offset:45824
s_branch K2BAR_148
K2SP_149:
s_cmp_eq_u32 s58, 0
s_cbranch_scc1 K2BAR_148
s_mov_b64 exec, s[68:69]
v_cvt_pk_bf16_f32 v8, v144, -v148
s_add_u32 s39, s55, 0
buffer_store_dword v8, v245, s[20:23], s39 offen sc1
v_cvt_pk_bf16_f32 v9, v145, -v149
s_add_u32 s39, s55, 32768
buffer_store_dword v9, v245, s[20:23], s39 offen sc1
v_cvt_pk_bf16_f32 v10, v146, -v150
s_add_u32 s39, s55, 65536
buffer_store_dword v10, v245, s[20:23], s39 offen sc1
v_cvt_pk_bf16_f32 v11, v147, -v151
s_add_u32 s39, s55, 98304
buffer_store_dword v11, v245, s[20:23], s39 offen sc1
v_cvt_pk_bf16_f32 v12, v152, -v156
s_add_u32 s39, s55, 524288
buffer_store_dword v12, v245, s[20:23], s39 offen sc1
v_cvt_pk_bf16_f32 v13, v153, -v157
s_add_u32 s39, s55, 557056
buffer_store_dword v13, v245, s[20:23], s39 offen sc1
v_cvt_pk_bf16_f32 v14, v154, -v158
s_add_u32 s39, s55, 589824
buffer_store_dword v14, v245, s[20:23], s39 offen sc1
v_cvt_pk_bf16_f32 v15, v155, -v159
s_add_u32 s39, s55, 622592
buffer_store_dword v15, v245, s[20:23], s39 offen sc1
v_cvt_pk_bf16_f32 v16, v160, -v164
s_add_u32 s39, s55, 1048576
buffer_store_dword v16, v245, s[20:23], s39 offen sc1
v_cvt_pk_bf16_f32 v17, v161, -v165
s_add_u32 s39, s55, 1081344
buffer_store_dword v17, v245, s[20:23], s39 offen sc1
v_cvt_pk_bf16_f32 v18, v162, -v166
s_add_u32 s39, s55, 1114112
buffer_store_dword v18, v245, s[20:23], s39 offen sc1
v_cvt_pk_bf16_f32 v19, v163, -v167
s_add_u32 s39, s55, 1146880
buffer_store_dword v19, v245, s[20:23], s39 offen sc1
v_cvt_pk_bf16_f32 v20, v168, -v172
s_add_u32 s39, s55, 1572864
buffer_store_dword v20, v245, s[20:23], s39 offen sc1
v_cvt_pk_bf16_f32 v21, v169, -v173
s_add_u32 s39, s55, 1605632
buffer_store_dword v21, v245, s[20:23], s39 offen sc1
v_cvt_pk_bf16_f32 v22, v170, -v174
s_add_u32 s39, s55, 1638400
buffer_store_dword v22, v245, s[20:23], s39 offen sc1
v_cvt_pk_bf16_f32 v23, v171, -v175
s_add_u32 s39, s55, 1671168
buffer_store_dword v23, v245, s[20:23], s39 offen sc1
s_mov_b64 exec, -1
K2BAR_148:
s_waitcnt lgkmcnt(0)
s_barrier
s_add_u32 s58, s58, 1
s_cmp_eq_u32 s58, 1
s_cbranch_scc1 K2REAL
ds_read_b128 v[32:35], v1 offset:0
ds_read_b128 v[36:39], v1 offset:1024
ds_read_b128 v[40:43], v1 offset:2048
ds_read_b128 v[44:47], v1 offset:3072
s_waitcnt lgkmcnt(3)
buffer_store_dwordx4 v[32:35], v244, s[20:23], s54 offen sc1
s_add_u32 s54, s54, 131072
s_waitcnt lgkmcnt(2)
buffer_store_dwordx4 v[36:39], v244, s[20:23], s54 offen sc1
s_add_u32 s54, s54, 131072
s_waitcnt lgkmcnt(1)
buffer_store_dwordx4 v[40:43], v244, s[20:23], s54 offen sc1
s_add_u32 s54, s54, 131072
s_waitcnt lgkmcnt(0)
buffer_store_dwordx4 v[44:47], v244, s[20:23], s54 offen sc1
s_add_u32 s54, s54, 131072
s_cmp_ge_u32 s51, 112
s_cbranch_scc1 K2E_150
ds_read_b128 v[48:51], v1 offset:32768
ds_read_b128 v[52:55], v1 offset:33792
ds_read_b128 v[56:59], v1 offset:34816
ds_read_b128 v[60:63], v1 offset:35840
s_waitcnt lgkmcnt(3)
buffer_store_dwordx4 v[48:51], v244, s[20:23], s55 offen sc1
s_add_u32 s55, s55, 131072
s_waitcnt lgkmcnt(2)
buffer_store_dwordx4 v[52:55], v244, s[20:23], s55 offen sc1
s_add_u32 s55, s55, 131072
s_waitcnt lgkmcnt(1)
buffer_store_dwordx4 v[56:59], v244, s[20:23], s55 offen sc1
s_add_u32 s55, s55, 131072
s_waitcnt lgkmcnt(0)
buffer_store_dwordx4 v[60:63], v244, s[20:23], s55 offen sc1
s_add_u32 s55, s55, 131072
K2E_150:
s_endpgm
K1END_1:
s_endpgm
.section .rodata,"a"
.p2align 6
.amdhsa_kernel parallel_sum__spectral_gfnet__dense_activation_gelu__prompt_kernel
  .amdhsa_next_free_vgpr 256
  .amdhsa_next_free_sgpr 96
  .amdhsa_accum_offset 256
  .amdhsa_group_segment_fixed_size 0
  .amdhsa_kernarg_size 88
  .amdhsa_user_sgpr_count 2
  .amdhsa_user_sgpr_kernarg_segment_ptr 1
  .amdhsa_system_sgpr_workgroup_id_x 1
.end_amdhsa_kernel
```
